```python
import torch

def _softmax(x, axis=-1):
    return torch.softmax(x, dim=axis)
def _gelu(x):
    return torch.nn.functional.gelu(x, approximate="tanh")
def _silu(x):
    return torch.nn.functional.silu(x)
def _sigmoid(x):
    return torch.sigmoid(x)
def _layernorm(x, axis=-1, eps=1e-5):
    m = x.mean(dim=axis, keepdim=True)
    v = x.var(dim=axis, keepdim=True, unbiased=False)
    return (x - m) / torch.sqrt(v + eps)
def _scatter_add(tgt, idx, src, axis=0):
    return tgt.clone().index_add_(axis, idx, src)
def _segment_sum(src, seg, n):
    out = torch.zeros((n,) + src.shape[1:], dtype=src.dtype)
    return out.index_add_(0, seg, src)
def _pad(x, pw):
    flat = tuple(v for pair in reversed(pw) for v in pair)
    return torch.nn.functional.pad(x, flat)

kernel_name = 'standalone__glu_gated_swiglu__prompt'

def setup_inputs():

    _w = (lambda a: (lambda t: t.to(torch.bfloat16) if t.is_floating_point() else t)(torch.as_tensor(a)))
    B, S, D, F = 1, 2048, 512, 1376
    return {
        "x": _w((lambda *s: torch.randn(*s, dtype=torch.bfloat16) * 0.05)(B, S, D)),
        "w1": _w((lambda *s: torch.randn(*s, dtype=torch.bfloat16) * 0.05)(D, F) * (2.0 / D) ** 0.5),
        "w3": _w((lambda *s: torch.randn(*s, dtype=torch.bfloat16) * 0.05)(D, F) * (2.0 / D) ** 0.5),
        "w2": _w((lambda *s: torch.randn(*s, dtype=torch.bfloat16) * 0.05)(F, D) * (2.0 / F) ** 0.5),
    }

def reference(x, w1, w3, w2):
    gate = torch.einsum("bsd,df->bsf", x, w1)
    up = torch.einsum("bsd,df->bsf", x, w3)
    h = _silu(gate) * up
    out = torch.einsum("bsf,fd->bsd", h, w2)
    return out
```

```asm
; @launch grid=(256,1,1) block=(512,1,1) lds=163840
.amdgcn_target "amdgcn-amd-amdhsa--gfx950"
.text
.globl standalone__glu_gated_swiglu__prompt_kernel
.p2align 8
.type standalone__glu_gated_swiglu__prompt_kernel,@function
standalone__glu_gated_swiglu__prompt_kernel:
    s_cmp_ge_u32 s2, 256
    s_cbranch_scc1 L_end
    s_load_dwordx8 s[4:11], s[0:1], 0
    v_readfirstlane_b32 s50, v0
    s_load_dwordx4 s[12:15], s[0:1], 32
    s_load_dwordx2 s[16:17], s[0:1], 48
    s_getpc_b64 s[84:85]
L_pc:
    s_lshr_b32 s86, s2, 3
    v_lshl_add_u32 v237, s86, 2, v0
    v_lshlrev_b32 v237, 7, v237
    v_cmp_gt_u32 vcc, 4, v0
    v_min_u32 v237, L_codeend-L_pc-4, v237
    s_and_saveexec_b64 s[86:87], vcc
    s_cbranch_execz L_nocpf
    global_load_dword v238, v237, s[84:85]
L_nocpf:
    s_mov_b64 exec, s[86:87]
    s_bitcmp1_b32 s50, 8
    s_cbranch_scc0 L_compute
    s_lshr_b32 s61, s2, 6
    s_lshr_b32 s52, s2, 3
    s_add_u32 s62, s61, s52
    s_and_b32 s62, s62, 3
    s_bfe_u32 s67, s50, 0x20006
    s_cmp_eq_u32 s67, 3
    s_cbranch_scc1 L_xload
    v_and_b32 v5, 255, v0
    s_and_b32 s61, s2, 3
    s_lshl2_add_u32 s54, s61, s62
    s_mul_i32 s56, s61, 22
    s_mul_i32 s63, s62, 6
    s_add_u32 s56, s56, s63
    s_min_u32 s56, s56, 82
    s_bitcmp1_b32 0xc888, s54
    s_cselect_b32 s57, 4, 6
    v_mul_u32_u24 v6, 43691, v5
    s_bfe_u32 s64, s56, 0x10001
    v_lshrrev_b32 v6, 19, v6
    s_bfe_u32 s65, s2, 0x10005
    v_mul_u32_u24 v7, 12, v6
    v_and_b32 v4, 8, v6
    v_lshlrev_b32 v4, 2, v4
    s_lshr_b32 s63, s2, 6
    v_xor_b32 v6, s64, v6
    s_lshl_b32 s64, s57, 1
    v_sub_u32 v7, v5, v7
    s_lshl_b32 s61, s56, 5
    v_mul_u32_u24 v6, 2752, v6
    v_cmp_le_u32 vcc, s64, v7
    s_mul_i32 s69, s63, 44032
    v_lshl_add_u32 v6, v7, 4, v6
    s_add_u32 s69, s69, s61
    v_bfrev_b32 v7, 2
    s_mul_i32 s62, s65, 12
    s_add_u32 s62, s62, s67
    v_cndmask_b32 v6, v6, v7, vcc
    s_add_u32 s62, s62, 16
    s_lshl_b32 s62, s62, 10
    s_mul_i32 s73, s63, 3072
    v_xor_b32 v10, v4, v6
    s_add_u32 s73, s73, s62
    s_mov_b32 s26, 1409024
    s_mov_b32 s27, 0x20000
    s_cmp_eq_u32 s65, 0
    s_waitcnt lgkmcnt(0)
    s_cselect_b32 s24, s6, s8
    s_cselect_b32 s25, s7, s9
    s_add_u32 m0, s73, 0
    s_add_u32 s86, s69, 0
    buffer_load_dwordx4 v10, s[24:27], s86 offen  lds
    s_add_u32 m0, s73, 40960
    s_add_u32 s86, s69, 176128
    buffer_load_dwordx4 v10, s[24:27], s86 offen  lds
    s_cmp_eq_u32 s65, 0
    s_cselect_b32 s28, s8, s6
    s_cselect_b32 s29, s9, s7
    s_mov_b32 s30, 1409024
    s_mov_b32 s31, 0x20000
    s_mov_b32 s64, 4294955008
    s_cmov_b32 s64, 12288
    s_add_u32 s77, s73, s64
    s_add_u32 s63, s63, 1
    s_and_b32 s63, s63, 3
    s_mul_i32 s70, s63, 44032
    s_add_u32 s70, s70, s61
    s_mul_i32 s74, s63, 3072
    s_add_u32 s74, s74, s62
    s_add_u32 s78, s74, s64
    s_add_u32 s63, s63, 1
    s_and_b32 s63, s63, 3
    s_mul_i32 s71, s63, 44032
    s_add_u32 s71, s71, s61
    s_mul_i32 s75, s63, 3072
    s_add_u32 s75, s75, s62
    s_add_u32 s79, s75, s64
    s_add_u32 s63, s63, 1
    s_and_b32 s63, s63, 3
    s_mul_i32 s72, s63, 44032
    s_add_u32 s72, s72, s61
    s_mul_i32 s76, s63, 3072
    s_add_u32 s76, s76, s62
    s_add_u32 s80, s76, s64
    v_and_b32 v0, 63, v0
    s_add_u32 m0, s77, 0
    s_add_u32 s86, s69, 0
    buffer_load_dwordx4 v10, s[28:31], s86 offen  lds
    s_add_u32 m0, s74, 0
    s_add_u32 s86, s70, 0
    buffer_load_dwordx4 v10, s[24:27], s86 offen  lds
    s_add_u32 m0, s78, 0
    s_nop 0
    buffer_load_dwordx4 v10, s[28:31], s86 offen  lds
    s_add_u32 m0, s75, 0
    s_add_u32 s86, s71, 0
    buffer_load_dwordx4 v10, s[24:27], s86 offen  lds
    s_add_u32 m0, s79, 0
    s_nop 0
    buffer_load_dwordx4 v10, s[28:31], s86 offen  lds
    s_add_u32 m0, s76, 0
    s_add_u32 s86, s72, 0
    buffer_load_dwordx4 v10, s[24:27], s86 offen  lds
    s_add_u32 m0, s80, 0
    s_nop 0
    buffer_load_dwordx4 v10, s[28:31], s86 offen  lds
    s_lshr_b32 s53, s2, 7
    s_and_b32 s63, s2, 7
    s_lshl3_add_u32 s58, s53, s63
    s_bfe_u32 s63, s2, 0x10006
    s_lshl1_add_u32 s59, s58, s63
    s_bfe_u32 s60, s2, 0x30003
    s_mov_b32 s66, 0
    v_mov_b32 v232, 81856
    s_lshl2_add_u32 s61, s67, 81856
    v_mov_b32 v233, s61
    v_lshrrev_b32 v2, 3, v0
    v_and_b32 v3, 7, v0
    v_bfe_u32 v5, v0, 4, 1
    v_lshlrev_b32 v5, 2, v5
    v_xor_b32 v5, v5, v3
    v_lshlrev_b32 v5, 4, v5
    v_lshl_add_u32 v5, v2, 10, v5
    s_lshl_b32 s61, s60, 7
    v_add_u32 v20, s61, v5
    s_mov_b64 s[32:33], s[10:11]
    s_mov_b32 s34, 1409024
    s_mov_b32 s35, 0x20000
    s_mov_b64 s[40:41], s[14:15]
    s_mov_b32 s42, 256
    s_mov_b32 s43, 0x20000
    s_mov_b64 s[44:45], s[16:17]
    s_mov_b32 s46, 6422528
    s_mov_b32 s47, 0x20000
    s_lshl_b32 s61, s67, 13
    s_mul_i32 s62, 0, 327680
    s_add_u32 s85, s61, s62
    s_mul_i32 s63, s66, 704512
    s_sub_u32 s64, 704512, s63
    s_add_u32 s62, s85, 65536
    s_add_u32 s81, s62, s63
    s_add_u32 s82, s62, s64
    s_cmp_eq_u32 0, 0
    s_cselect_b32 s62, 376832, 0
    s_add_u32 s62, s62, s61
    s_add_u32 s83, s62, s63
    s_add_u32 s84, s62, s64
    s_lshl_b32 s91, s67, 10
    s_add_u32 m0, s77, 40960
    s_add_u32 s86, s69, 176128
    buffer_load_dwordx4 v10, s[28:31], s86 offen  lds
    s_add_u32 m0, s74, 40960
    s_add_u32 s86, s70, 176128
    buffer_load_dwordx4 v10, s[24:27], s86 offen  lds
    s_add_u32 m0, s78, 40960
    s_nop 0
    buffer_load_dwordx4 v10, s[28:31], s86 offen  lds
    s_add_u32 m0, s75, 40960
    s_add_u32 s86, s71, 176128
    buffer_load_dwordx4 v10, s[24:27], s86 offen  lds
    s_add_u32 m0, s79, 40960
    s_nop 0
    buffer_load_dwordx4 v10, s[28:31], s86 offen  lds
    s_add_u32 m0, s76, 40960
    s_add_u32 s86, s72, 176128
    buffer_load_dwordx4 v10, s[24:27], s86 offen  lds
    s_add_u32 m0, s80, 40960
    s_nop 0
    buffer_load_dwordx4 v10, s[28:31], s86 offen  lds
    s_waitcnt vmcnt(7)
    s_barrier
    s_add_u32 m0, s73, 81920
    s_add_u32 s86, s69, 352256
    buffer_load_dwordx4 v10, s[24:27], s86 offen  lds
    s_add_u32 m0, s73, 122880
    s_add_u32 s86, s69, 528384
    buffer_load_dwordx4 v10, s[24:27], s86 offen  lds
    s_add_u32 m0, s77, 81920
    s_add_u32 s86, s69, 352256
    buffer_load_dwordx4 v10, s[28:31], s86 offen  lds
    s_add_u32 m0, s74, 81920
    s_add_u32 s86, s70, 352256
    buffer_load_dwordx4 v10, s[24:27], s86 offen  lds
    s_add_u32 m0, s78, 81920
    s_nop 0
    buffer_load_dwordx4 v10, s[28:31], s86 offen  lds
    s_add_u32 m0, s75, 81920
    s_add_u32 s86, s71, 352256
    buffer_load_dwordx4 v10, s[24:27], s86 offen  lds
    s_waitcnt vmcnt(6)
    s_barrier
    s_add_u32 m0, s79, 81920
    s_nop 0
    buffer_load_dwordx4 v10, s[28:31], s86 offen  lds
    s_add_u32 m0, s76, 81920
    s_add_u32 s86, s72, 352256
    buffer_load_dwordx4 v10, s[24:27], s86 offen  lds
    s_add_u32 m0, s80, 81920
    s_nop 0
    buffer_load_dwordx4 v10, s[28:31], s86 offen  lds
    s_add_u32 m0, s77, 122880
    s_add_u32 s86, s69, 528384
    buffer_load_dwordx4 v10, s[28:31], s86 offen  lds
    s_add_u32 m0, s74, 122880
    s_add_u32 s86, s70, 528384
    buffer_load_dwordx4 v10, s[24:27], s86 offen  lds
    s_add_u32 m0, s78, 122880
    s_nop 0
    buffer_load_dwordx4 v10, s[28:31], s86 offen  lds
    s_add_u32 m0, s75, 122880
    s_add_u32 s86, s71, 528384
    buffer_load_dwordx4 v10, s[24:27], s86 offen  lds
    s_add_u32 m0, s79, 122880
    s_nop 0
    buffer_load_dwordx4 v10, s[28:31], s86 offen  lds
    s_add_u32 m0, s76, 122880
    s_add_u32 s86, s72, 528384
    buffer_load_dwordx4 v10, s[24:27], s86 offen  lds
    s_add_u32 m0, s80, 122880
    s_nop 0
    buffer_load_dwordx4 v10, s[28:31], s86 offen  lds
    s_waitcnt vmcnt(7)
    s_barrier
    s_add_u32 m0, s73, 0
    s_add_u32 s86, s69, 704512
    buffer_load_dwordx4 v10, s[24:27], s86 offen  lds
    s_add_u32 m0, s73, 40960
    s_add_u32 s86, s69, 880640
    buffer_load_dwordx4 v10, s[24:27], s86 offen  lds
    s_add_u32 m0, s77, 0
    s_add_u32 s86, s69, 704512
    buffer_load_dwordx4 v10, s[28:31], s86 offen  lds
    s_add_u32 m0, s74, 0
    s_add_u32 s86, s70, 704512
    buffer_load_dwordx4 v10, s[24:27], s86 offen  lds
    s_add_u32 m0, s78, 0
    s_nop 0
    buffer_load_dwordx4 v10, s[28:31], s86 offen  lds
    s_add_u32 m0, s75, 0
    s_add_u32 s86, s71, 704512
    buffer_load_dwordx4 v10, s[24:27], s86 offen  lds
    s_waitcnt vmcnt(6)
    s_barrier
    s_add_u32 m0, s79, 0
    s_nop 0
    buffer_load_dwordx4 v10, s[28:31], s86 offen  lds
    s_add_u32 m0, s76, 0
    s_add_u32 s86, s72, 704512
    buffer_load_dwordx4 v10, s[24:27], s86 offen  lds
    s_add_u32 m0, s80, 0
    s_nop 0
    buffer_load_dwordx4 v10, s[28:31], s86 offen  lds
    s_add_u32 m0, s77, 40960
    s_add_u32 s86, s69, 880640
    buffer_load_dwordx4 v10, s[28:31], s86 offen  lds
    s_add_u32 m0, s74, 40960
    s_add_u32 s86, s70, 880640
    buffer_load_dwordx4 v10, s[24:27], s86 offen  lds
    s_add_u32 m0, s78, 40960
    s_nop 0
    buffer_load_dwordx4 v10, s[28:31], s86 offen  lds
    s_add_u32 m0, s75, 40960
    s_add_u32 s86, s71, 880640
    buffer_load_dwordx4 v10, s[24:27], s86 offen  lds
    s_add_u32 m0, s79, 40960
    s_nop 0
    buffer_load_dwordx4 v10, s[28:31], s86 offen  lds
    s_add_u32 m0, s76, 40960
    s_add_u32 s86, s72, 880640
    buffer_load_dwordx4 v10, s[24:27], s86 offen  lds
    s_add_u32 m0, s80, 40960
    s_nop 0
    buffer_load_dwordx4 v10, s[28:31], s86 offen  lds
    s_waitcnt vmcnt(7)
    s_barrier
    s_add_u32 m0, s73, 81920
    s_add_u32 s86, s69, 1056768
    buffer_load_dwordx4 v10, s[24:27], s86 offen  lds
    s_add_u32 m0, s73, 122880
    s_add_u32 s86, s69, 1232896
    buffer_load_dwordx4 v10, s[24:27], s86 offen  lds
    s_add_u32 m0, s77, 81920
    s_add_u32 s86, s69, 1056768
    buffer_load_dwordx4 v10, s[28:31], s86 offen  lds
    s_add_u32 m0, s74, 81920
    s_add_u32 s86, s70, 1056768
    buffer_load_dwordx4 v10, s[24:27], s86 offen  lds
    s_add_u32 m0, s78, 81920
    s_nop 0
    buffer_load_dwordx4 v10, s[28:31], s86 offen  lds
    s_add_u32 m0, s75, 81920
    s_add_u32 s86, s71, 1056768
    buffer_load_dwordx4 v10, s[24:27], s86 offen  lds
    s_waitcnt vmcnt(6)
    s_barrier
    s_add_u32 m0, s79, 81920
    s_nop 0
    buffer_load_dwordx4 v10, s[28:31], s86 offen  lds
    s_add_u32 m0, s76, 81920
    s_add_u32 s86, s72, 1056768
    buffer_load_dwordx4 v10, s[24:27], s86 offen  lds
    s_add_u32 m0, s80, 81920
    s_nop 0
    buffer_load_dwordx4 v10, s[28:31], s86 offen  lds
    s_add_u32 m0, s77, 122880
    s_add_u32 s86, s69, 1232896
    buffer_load_dwordx4 v10, s[28:31], s86 offen  lds
    s_add_u32 m0, s74, 122880
    s_add_u32 s86, s70, 1232896
    buffer_load_dwordx4 v10, s[24:27], s86 offen  lds
    s_add_u32 m0, s78, 122880
    s_nop 0
    buffer_load_dwordx4 v10, s[28:31], s86 offen  lds
    s_add_u32 m0, s75, 122880
    s_add_u32 s86, s71, 1232896
    buffer_load_dwordx4 v10, s[24:27], s86 offen  lds
    s_add_u32 m0, s79, 122880
    s_nop 0
    buffer_load_dwordx4 v10, s[28:31], s86 offen  lds
    s_add_u32 m0, s76, 122880
    s_add_u32 s86, s72, 1232896
    buffer_load_dwordx4 v10, s[24:27], s86 offen  lds
    s_add_u32 m0, s80, 122880
    s_nop 0
    buffer_load_dwordx4 v10, s[28:31], s86 offen  lds
    buffer_load_dwordx2 v[28:29], off, s[40:43], 0 sc1
    s_waitcnt vmcnt(8)
    s_barrier
    s_add_u32 m0, s91, 0
    s_add_u32 s86, s85, 0
    buffer_load_dwordx4 v20, s[32:35], s86 offen lds
    s_add_u32 m0, s91, 4096
    s_add_u32 s86, s85, 32768
    buffer_load_dwordx4 v20, s[32:35], s86 offen lds
    s_add_u32 m0, s91, 8192
    s_add_u32 s86, s85, 704512
    buffer_load_dwordx4 v20, s[32:35], s86 offen lds
    s_add_u32 m0, s91, 12288
    s_add_u32 s86, s85, 737280
    buffer_load_dwordx4 v20, s[32:35], s86 offen lds
    s_add_u32 m0, s91, 40960
    s_add_u32 s86, s81, 0
    buffer_load_dwordx4 v20, s[32:35], s86 offen lds
    s_add_u32 m0, s91, 45056
    s_add_u32 s86, s81, 32768
    buffer_load_dwordx4 v20, s[32:35], s86 offen lds
    s_add_u32 m0, s91, 49152
    s_add_u32 s86, s81, 65536
    buffer_load_dwordx4 v20, s[32:35], s86 offen lds
    s_add_u32 m0, s91, 53248
    s_add_u32 s86, s81, 98304
    buffer_load_dwordx4 v20, s[32:35], s86 offen lds
    s_add_u32 m0, s91, 57344
    s_add_u32 s86, s81, 131072
    buffer_load_dwordx4 v20, s[32:35], s86 offen lds
    s_waitcnt vmcnt(10)
    s_barrier
    s_branch L_join
L_xload:
    v_and_b32 v0, 63, v0
    s_lshr_b32 s53, s2, 7
    s_and_b32 s61, s2, 4
    s_lshl3_add_u32 s55, s53, s61
    s_bfe_u32 s61, s2, 0x20005
    s_add_u32 s55, s55, s61
    v_lshrrev_b32 v2, 3, v0
    v_and_b32 v3, 7, v0
    v_lshrrev_b32 v4, 4, v0
    v_xor_b32 v5, v4, v3
    v_lshlrev_b32 v5, 4, v5
    v_lshl_add_u32 v10, v2, 10, v5
    v_xor_b32 v5, 64, v10
    v_add_u32 v11, 7168, v5
    v_add_u32 v12, 14336, v10
    v_add_u32 v13, 21504, v5
    s_lshl_b32 s61, s55, 17
    s_lshl_b32 s73, s62, 12
    s_lshl3_add_u32 s69, s73, s61
    s_mov_b32 s22, 2097152
    s_mov_b32 s23, 0x20000
    s_waitcnt lgkmcnt(0)
    s_mov_b64 s[20:21], s[4:5]
    s_add_u32 s86, s69, 0
    s_add_u32 m0, s73, 0
    s_nop 0
    buffer_load_dwordx4 v10, s[20:23], s86 offen offset:0  lds
    buffer_load_dwordx4 v11, s[20:23], s86 offen offset:1024  lds
    buffer_load_dwordx4 v12, s[20:23], s86 offen offset:2048  lds
    buffer_load_dwordx4 v13, s[20:23], s86 offen offset:3072  lds
    s_add_u32 s86, s69, 128
    s_add_u32 m0, s73, 40960
    s_nop 0
    buffer_load_dwordx4 v10, s[20:23], s86 offen offset:0  lds
    buffer_load_dwordx4 v11, s[20:23], s86 offen offset:1024  lds
    buffer_load_dwordx4 v12, s[20:23], s86 offen offset:2048  lds
    buffer_load_dwordx4 v13, s[20:23], s86 offen offset:3072  lds
    s_add_u32 s62, s62, 1
    s_and_b32 s62, s62, 3
    s_lshl_b32 s74, s62, 12
    s_lshl3_add_u32 s70, s74, s61
    s_add_u32 s62, s62, 1
    s_and_b32 s62, s62, 3
    s_lshl_b32 s75, s62, 12
    s_lshl3_add_u32 s71, s75, s61
    s_add_u32 s62, s62, 1
    s_and_b32 s62, s62, 3
    s_lshl_b32 s76, s62, 12
    s_lshl3_add_u32 s72, s76, s61
    s_add_u32 s86, s70, 0
    s_add_u32 m0, s74, 0
    s_nop 0
    buffer_load_dwordx4 v10, s[20:23], s86 offen offset:0  lds
    buffer_load_dwordx4 v11, s[20:23], s86 offen offset:1024  lds
    buffer_load_dwordx4 v12, s[20:23], s86 offen offset:2048  lds
    buffer_load_dwordx4 v13, s[20:23], s86 offen offset:3072  lds
    s_add_u32 s86, s71, 0
    s_add_u32 m0, s75, 0
    s_nop 0
    buffer_load_dwordx4 v10, s[20:23], s86 offen offset:0  lds
    buffer_load_dwordx4 v11, s[20:23], s86 offen offset:1024  lds
    buffer_load_dwordx4 v12, s[20:23], s86 offen offset:2048  lds
    buffer_load_dwordx4 v13, s[20:23], s86 offen offset:3072  lds
    s_add_u32 s86, s72, 0
    s_add_u32 m0, s76, 0
    s_nop 0
    buffer_load_dwordx4 v10, s[20:23], s86 offen offset:0  lds
    buffer_load_dwordx4 v11, s[20:23], s86 offen offset:1024  lds
    buffer_load_dwordx4 v12, s[20:23], s86 offen offset:2048  lds
    buffer_load_dwordx4 v13, s[20:23], s86 offen offset:3072  lds
    s_lshr_b32 s53, s2, 7
    s_and_b32 s63, s2, 7
    s_lshl3_add_u32 s58, s53, s63
    s_bfe_u32 s63, s2, 0x10006
    s_lshl1_add_u32 s59, s58, s63
    s_bfe_u32 s60, s2, 0x30003
    s_mov_b32 s66, 0
    v_mov_b32 v232, 81856
    s_lshl2_add_u32 s61, s67, 81856
    v_mov_b32 v233, s61
    v_lshrrev_b32 v2, 3, v0
    v_and_b32 v3, 7, v0
    v_bfe_u32 v5, v0, 4, 1
    v_lshlrev_b32 v5, 2, v5
    v_xor_b32 v5, v5, v3
    v_lshlrev_b32 v5, 4, v5
    v_lshl_add_u32 v5, v2, 10, v5
    s_lshl_b32 s61, s60, 7
    v_add_u32 v20, s61, v5
    s_mov_b64 s[32:33], s[10:11]
    s_mov_b32 s34, 1409024
    s_mov_b32 s35, 0x20000
    s_mov_b64 s[40:41], s[14:15]
    s_mov_b32 s42, 256
    s_mov_b32 s43, 0x20000
    s_mov_b64 s[44:45], s[16:17]
    s_mov_b32 s46, 6422528
    s_mov_b32 s47, 0x20000
    s_lshl_b32 s61, s67, 13
    s_mul_i32 s62, 0, 327680
    s_add_u32 s85, s61, s62
    s_mul_i32 s63, s66, 704512
    s_sub_u32 s64, 704512, s63
    s_add_u32 s62, s85, 65536
    s_add_u32 s81, s62, s63
    s_add_u32 s82, s62, s64
    s_cmp_eq_u32 0, 0
    s_cselect_b32 s62, 376832, 0
    s_add_u32 s62, s62, s61
    s_add_u32 s83, s62, s63
    s_add_u32 s84, s62, s64
    s_lshl_b32 s91, s67, 10
    s_mov_b64 s[32:33], s[10:11]
    s_mov_b32 s34, 1409024
    s_mov_b32 s35, 0x20000
    v_lshlrev_b32 v30, 7, v0
    s_lshr_b32 s88, s2, 5
    s_and_b32 s87, s2, 7
    s_lshl3_add_u32 s87, s87, s88
    s_mul_i32 s87, s87, 22016
    s_lshr_b32 s88, s2, 3
    s_mul_i32 s88, s88, 44032
    s_cmp_lg_u32 s73, 12288
    s_cmov_b32 s87, 0x40000000
    v_lshlrev_b32 v32, 10, v0
    s_add_u32 s86, s70, 128
    s_add_u32 m0, s74, 40960
    s_nop 0
    buffer_load_dwordx4 v10, s[20:23], s86 offen offset:0  lds
    buffer_load_dwordx4 v11, s[20:23], s86 offen offset:1024  lds
    buffer_load_dwordx4 v12, s[20:23], s86 offen offset:2048  lds
    buffer_load_dwordx4 v13, s[20:23], s86 offen offset:3072  lds
    s_add_u32 s86, s71, 128
    s_add_u32 m0, s75, 40960
    s_nop 0
    buffer_load_dwordx4 v10, s[20:23], s86 offen offset:0  lds
    buffer_load_dwordx4 v11, s[20:23], s86 offen offset:1024  lds
    buffer_load_dwordx4 v12, s[20:23], s86 offen offset:2048  lds
    buffer_load_dwordx4 v13, s[20:23], s86 offen offset:3072  lds
    s_add_u32 s86, s72, 128
    s_add_u32 m0, s76, 40960
    s_nop 0
    buffer_load_dwordx4 v10, s[20:23], s86 offen offset:0  lds
    buffer_load_dwordx4 v11, s[20:23], s86 offen offset:1024  lds
    buffer_load_dwordx4 v12, s[20:23], s86 offen offset:2048  lds
    buffer_load_dwordx4 v13, s[20:23], s86 offen offset:3072  lds
    s_waitcnt vmcnt(12)
    s_barrier
    s_add_u32 s86, s87, 0
    s_mov_b32 exec_hi, 67108863
    buffer_load_dword v31, v30, s[32:35], s86 offen
    s_mov_b64 exec, -1
    s_mov_b64 exec, 32767
    s_add_u32 s86, s88, 384
    buffer_load_dword v31, v32, s[32:35], s86 offen
    s_mov_b64 exec, -1
    s_add_u32 s86, s69, 256
    s_add_u32 m0, s73, 81920
    s_nop 0
    buffer_load_dwordx4 v10, s[20:23], s86 offen offset:0  lds
    buffer_load_dwordx4 v11, s[20:23], s86 offen offset:1024  lds
    buffer_load_dwordx4 v12, s[20:23], s86 offen offset:2048  lds
    buffer_load_dwordx4 v13, s[20:23], s86 offen offset:3072  lds
    s_add_u32 s86, s69, 384
    s_add_u32 m0, s73, 122880
    s_nop 0
    buffer_load_dwordx4 v10, s[20:23], s86 offen offset:0  lds
    buffer_load_dwordx4 v11, s[20:23], s86 offen offset:1024  lds
    buffer_load_dwordx4 v12, s[20:23], s86 offen offset:2048  lds
    buffer_load_dwordx4 v13, s[20:23], s86 offen offset:3072  lds
    s_add_u32 s86, s70, 256
    s_add_u32 m0, s74, 81920
    s_nop 0
    buffer_load_dwordx4 v10, s[20:23], s86 offen offset:0  lds
    buffer_load_dwordx4 v11, s[20:23], s86 offen offset:1024  lds
    buffer_load_dwordx4 v12, s[20:23], s86 offen offset:2048  lds
    buffer_load_dwordx4 v13, s[20:23], s86 offen offset:3072  lds
    s_add_u32 s86, s71, 256
    s_add_u32 m0, s75, 81920
    s_nop 0
    buffer_load_dwordx4 v10, s[20:23], s86 offen offset:0  lds
    buffer_load_dwordx4 v11, s[20:23], s86 offen offset:1024  lds
    buffer_load_dwordx4 v12, s[20:23], s86 offen offset:2048  lds
    buffer_load_dwordx4 v13, s[20:23], s86 offen offset:3072  lds
    s_waitcnt vmcnt(18)
    s_barrier
    s_add_u32 s86, s72, 256
    s_add_u32 m0, s76, 81920
    s_nop 0
    buffer_load_dwordx4 v10, s[20:23], s86 offen offset:0  lds
    buffer_load_dwordx4 v11, s[20:23], s86 offen offset:1024  lds
    buffer_load_dwordx4 v12, s[20:23], s86 offen offset:2048  lds
    buffer_load_dwordx4 v13, s[20:23], s86 offen offset:3072  lds
    s_add_u32 s86, s70, 384
    s_add_u32 m0, s74, 122880
    s_nop 0
    buffer_load_dwordx4 v10, s[20:23], s86 offen offset:0  lds
    buffer_load_dwordx4 v11, s[20:23], s86 offen offset:1024  lds
    buffer_load_dwordx4 v12, s[20:23], s86 offen offset:2048  lds
    buffer_load_dwordx4 v13, s[20:23], s86 offen offset:3072  lds
    s_add_u32 s86, s71, 384
    s_add_u32 m0, s75, 122880
    s_nop 0
    buffer_load_dwordx4 v10, s[20:23], s86 offen offset:0  lds
    buffer_load_dwordx4 v11, s[20:23], s86 offen offset:1024  lds
    buffer_load_dwordx4 v12, s[20:23], s86 offen offset:2048  lds
    buffer_load_dwordx4 v13, s[20:23], s86 offen offset:3072  lds
    s_add_u32 s86, s72, 384
    s_add_u32 m0, s76, 122880
    s_nop 0
    buffer_load_dwordx4 v10, s[20:23], s86 offen offset:0  lds
    buffer_load_dwordx4 v11, s[20:23], s86 offen offset:1024  lds
    buffer_load_dwordx4 v12, s[20:23], s86 offen offset:2048  lds
    buffer_load_dwordx4 v13, s[20:23], s86 offen offset:3072  lds
    s_waitcnt vmcnt(12)
    s_barrier
    s_add_u32 s86, s87, 7424
    s_mov_b32 exec_hi, 67108863
    buffer_load_dword v31, v30, s[32:35], s86 offen
    s_mov_b64 exec, -1
    s_mov_b64 exec, 32767
    s_add_u32 s86, s88, 15744
    buffer_load_dword v31, v32, s[32:35], s86 offen
    s_mov_b64 exec, -1
    s_add_u32 s86, s69, 512
    s_add_u32 m0, s73, 0
    s_nop 0
    buffer_load_dwordx4 v10, s[20:23], s86 offen offset:0  lds
    buffer_load_dwordx4 v11, s[20:23], s86 offen offset:1024  lds
    buffer_load_dwordx4 v12, s[20:23], s86 offen offset:2048  lds
    buffer_load_dwordx4 v13, s[20:23], s86 offen offset:3072  lds
    s_add_u32 s86, s69, 640
    s_add_u32 m0, s73, 40960
    s_nop 0
    buffer_load_dwordx4 v10, s[20:23], s86 offen offset:0  lds
    buffer_load_dwordx4 v11, s[20:23], s86 offen offset:1024  lds
    buffer_load_dwordx4 v12, s[20:23], s86 offen offset:2048  lds
    buffer_load_dwordx4 v13, s[20:23], s86 offen offset:3072  lds
    s_add_u32 s86, s70, 512
    s_add_u32 m0, s74, 0
    s_nop 0
    buffer_load_dwordx4 v10, s[20:23], s86 offen offset:0  lds
    buffer_load_dwordx4 v11, s[20:23], s86 offen offset:1024  lds
    buffer_load_dwordx4 v12, s[20:23], s86 offen offset:2048  lds
    buffer_load_dwordx4 v13, s[20:23], s86 offen offset:3072  lds
    s_add_u32 s86, s71, 512
    s_add_u32 m0, s75, 0
    s_nop 0
    buffer_load_dwordx4 v10, s[20:23], s86 offen offset:0  lds
    buffer_load_dwordx4 v11, s[20:23], s86 offen offset:1024  lds
    buffer_load_dwordx4 v12, s[20:23], s86 offen offset:2048  lds
    buffer_load_dwordx4 v13, s[20:23], s86 offen offset:3072  lds
    s_waitcnt vmcnt(18)
    s_barrier
    s_add_u32 s86, s72, 512
    s_add_u32 m0, s76, 0
    s_nop 0
    buffer_load_dwordx4 v10, s[20:23], s86 offen offset:0  lds
    buffer_load_dwordx4 v11, s[20:23], s86 offen offset:1024  lds
    buffer_load_dwordx4 v12, s[20:23], s86 offen offset:2048  lds
    buffer_load_dwordx4 v13, s[20:23], s86 offen offset:3072  lds
    s_add_u32 s86, s70, 640
    s_add_u32 m0, s74, 40960
    s_nop 0
    buffer_load_dwordx4 v10, s[20:23], s86 offen offset:0  lds
    buffer_load_dwordx4 v11, s[20:23], s86 offen offset:1024  lds
    buffer_load_dwordx4 v12, s[20:23], s86 offen offset:2048  lds
    buffer_load_dwordx4 v13, s[20:23], s86 offen offset:3072  lds
    s_add_u32 s86, s71, 640
    s_add_u32 m0, s75, 40960
    s_nop 0
    buffer_load_dwordx4 v10, s[20:23], s86 offen offset:0  lds
    buffer_load_dwordx4 v11, s[20:23], s86 offen offset:1024  lds
    buffer_load_dwordx4 v12, s[20:23], s86 offen offset:2048  lds
    buffer_load_dwordx4 v13, s[20:23], s86 offen offset:3072  lds
    s_add_u32 s86, s72, 640
    s_add_u32 m0, s76, 40960
    s_nop 0
    buffer_load_dwordx4 v10, s[20:23], s86 offen offset:0  lds
    buffer_load_dwordx4 v11, s[20:23], s86 offen offset:1024  lds
    buffer_load_dwordx4 v12, s[20:23], s86 offen offset:2048  lds
    buffer_load_dwordx4 v13, s[20:23], s86 offen offset:3072  lds
    s_waitcnt vmcnt(12)
    s_barrier
    s_add_u32 s86, s87, 14848
    s_mov_b32 exec_hi, 67108863
    buffer_load_dword v31, v30, s[32:35], s86 offen
    s_mov_b64 exec, -1
    s_mov_b64 exec, 32767
    s_add_u32 s86, s88, 31104
    buffer_load_dword v31, v32, s[32:35], s86 offen
    s_mov_b64 exec, -1
    s_add_u32 s86, s69, 768
    s_add_u32 m0, s73, 81920
    s_nop 0
    buffer_load_dwordx4 v10, s[20:23], s86 offen offset:0  lds
    buffer_load_dwordx4 v11, s[20:23], s86 offen offset:1024  lds
    buffer_load_dwordx4 v12, s[20:23], s86 offen offset:2048  lds
    buffer_load_dwordx4 v13, s[20:23], s86 offen offset:3072  lds
    s_add_u32 s86, s69, 896
    s_add_u32 m0, s73, 122880
    s_nop 0
    buffer_load_dwordx4 v10, s[20:23], s86 offen offset:0  lds
    buffer_load_dwordx4 v11, s[20:23], s86 offen offset:1024  lds
    buffer_load_dwordx4 v12, s[20:23], s86 offen offset:2048  lds
    buffer_load_dwordx4 v13, s[20:23], s86 offen offset:3072  lds
    s_add_u32 s86, s70, 768
    s_add_u32 m0, s74, 81920
    s_nop 0
    buffer_load_dwordx4 v10, s[20:23], s86 offen offset:0  lds
    buffer_load_dwordx4 v11, s[20:23], s86 offen offset:1024  lds
    buffer_load_dwordx4 v12, s[20:23], s86 offen offset:2048  lds
    buffer_load_dwordx4 v13, s[20:23], s86 offen offset:3072  lds
    s_add_u32 s86, s71, 768
    s_add_u32 m0, s75, 81920
    s_nop 0
    buffer_load_dwordx4 v10, s[20:23], s86 offen offset:0  lds
    buffer_load_dwordx4 v11, s[20:23], s86 offen offset:1024  lds
    buffer_load_dwordx4 v12, s[20:23], s86 offen offset:2048  lds
    buffer_load_dwordx4 v13, s[20:23], s86 offen offset:3072  lds
    s_waitcnt vmcnt(18)
    s_barrier
    s_add_u32 s86, s72, 768
    s_add_u32 m0, s76, 81920
    s_nop 0
    buffer_load_dwordx4 v10, s[20:23], s86 offen offset:0  lds
    buffer_load_dwordx4 v11, s[20:23], s86 offen offset:1024  lds
    buffer_load_dwordx4 v12, s[20:23], s86 offen offset:2048  lds
    buffer_load_dwordx4 v13, s[20:23], s86 offen offset:3072  lds
    s_add_u32 s86, s70, 896
    s_add_u32 m0, s74, 122880
    s_nop 0
    buffer_load_dwordx4 v10, s[20:23], s86 offen offset:0  lds
    buffer_load_dwordx4 v11, s[20:23], s86 offen offset:1024  lds
    buffer_load_dwordx4 v12, s[20:23], s86 offen offset:2048  lds
    buffer_load_dwordx4 v13, s[20:23], s86 offen offset:3072  lds
    s_add_u32 s86, s71, 896
    s_add_u32 m0, s75, 122880
    s_nop 0
    buffer_load_dwordx4 v10, s[20:23], s86 offen offset:0  lds
    buffer_load_dwordx4 v11, s[20:23], s86 offen offset:1024  lds
    buffer_load_dwordx4 v12, s[20:23], s86 offen offset:2048  lds
    buffer_load_dwordx4 v13, s[20:23], s86 offen offset:3072  lds
    s_add_u32 s86, s72, 896
    s_add_u32 m0, s76, 122880
    s_nop 0
    buffer_load_dwordx4 v10, s[20:23], s86 offen offset:0  lds
    buffer_load_dwordx4 v11, s[20:23], s86 offen offset:1024  lds
    buffer_load_dwordx4 v12, s[20:23], s86 offen offset:2048  lds
    buffer_load_dwordx4 v13, s[20:23], s86 offen offset:3072  lds
    buffer_load_dwordx2 v[28:29], off, s[40:43], 0 sc1
    s_waitcnt vmcnt(13)
    s_barrier
    s_add_u32 m0, s91, 0
    s_add_u32 s86, s85, 0
    buffer_load_dwordx4 v20, s[32:35], s86 offen lds
    s_add_u32 m0, s91, 4096
    s_add_u32 s86, s85, 32768
    buffer_load_dwordx4 v20, s[32:35], s86 offen lds
    s_add_u32 m0, s91, 8192
    s_add_u32 s86, s85, 704512
    buffer_load_dwordx4 v20, s[32:35], s86 offen lds
    s_add_u32 m0, s91, 12288
    s_add_u32 s86, s85, 737280
    buffer_load_dwordx4 v20, s[32:35], s86 offen lds
    s_add_u32 m0, s91, 40960
    s_add_u32 s86, s81, 0
    buffer_load_dwordx4 v20, s[32:35], s86 offen lds
    s_add_u32 m0, s91, 45056
    s_add_u32 s86, s81, 32768
    buffer_load_dwordx4 v20, s[32:35], s86 offen lds
    s_add_u32 m0, s91, 49152
    s_add_u32 s86, s81, 65536
    buffer_load_dwordx4 v20, s[32:35], s86 offen lds
    s_add_u32 m0, s91, 53248
    s_add_u32 s86, s81, 98304
    buffer_load_dwordx4 v20, s[32:35], s86 offen lds
    s_add_u32 m0, s91, 57344
    s_add_u32 s86, s81, 131072
    buffer_load_dwordx4 v20, s[32:35], s86 offen lds
    s_waitcnt vmcnt(10)
    s_barrier
L_join:
    s_add_u32 m0, s91, 61440
    s_add_u32 s86, s81, 163840
    buffer_load_dwordx4 v20, s[32:35], s86 offen lds
    s_add_u32 m0, s91, 65536
    s_add_u32 s86, s81, 196608
    buffer_load_dwordx4 v20, s[32:35], s86 offen lds
    s_add_u32 m0, s91, 69632
    s_add_u32 s86, s81, 229376
    buffer_load_dwordx4 v20, s[32:35], s86 offen lds
    s_add_u32 m0, s91, 73728
    s_add_u32 s86, s81, 262144
    buffer_load_dwordx4 v20, s[32:35], s86 offen lds
    s_cmp_lt_u32 s67, 2
    s_cselect_b32 s61, 0, 4096
    s_add_u32 m0, s91, 77824
    s_sub_u32 m0, m0, s61
    s_lshl_b32 s61, s61, 3
    s_add_u32 s86, s81, 294912
    s_sub_u32 s86, s86, s61
    buffer_load_dwordx4 v20, s[32:35], s86 offen lds
    s_add_u32 m0, s91, 81920
    s_add_u32 s86, s82, 0
    buffer_load_dwordx4 v20, s[32:35], s86 offen lds
    s_add_u32 m0, s91, 86016
    s_add_u32 s86, s82, 32768
    buffer_load_dwordx4 v20, s[32:35], s86 offen lds
    s_add_u32 m0, s91, 90112
    s_add_u32 s86, s82, 65536
    buffer_load_dwordx4 v20, s[32:35], s86 offen lds
    s_add_u32 m0, s91, 94208
    s_add_u32 s86, s82, 98304
    buffer_load_dwordx4 v20, s[32:35], s86 offen lds
    s_add_u32 m0, s91, 98304
    s_add_u32 s86, s82, 131072
    buffer_load_dwordx4 v20, s[32:35], s86 offen lds
    s_barrier
    s_add_u32 m0, s91, 102400
    s_add_u32 s86, s82, 163840
    buffer_load_dwordx4 v20, s[32:35], s86 offen lds
    s_add_u32 m0, s91, 106496
    s_add_u32 s86, s82, 196608
    buffer_load_dwordx4 v20, s[32:35], s86 offen lds
    s_add_u32 m0, s91, 110592
    s_add_u32 s86, s82, 229376
    buffer_load_dwordx4 v20, s[32:35], s86 offen lds
    s_add_u32 m0, s91, 114688
    s_add_u32 s86, s82, 262144
    buffer_load_dwordx4 v20, s[32:35], s86 offen lds
    s_cmp_lt_u32 s67, 2
    s_cselect_b32 s61, 0, 4096
    s_add_u32 m0, s91, 118784
    s_sub_u32 m0, m0, s61
    s_lshl_b32 s61, s61, 3
    s_add_u32 s86, s82, 294912
    s_sub_u32 s86, s86, s61
    buffer_load_dwordx4 v20, s[32:35], s86 offen lds
    s_waitcnt vmcnt(0)
    v_mov_b32 v234, 9
    s_mov_b64 exec, 1
    ds_write_b32 v233, v234
    s_mov_b64 exec, -1
    s_add_u32 m0, s91, 122880
    s_add_u32 s86, s83, 0
    buffer_load_dwordx4 v20, s[32:35], s86 offen lds
    s_add_u32 m0, s91, 126976
    s_add_u32 s86, s83, 32768
    buffer_load_dwordx4 v20, s[32:35], s86 offen lds
    s_add_u32 m0, s91, 131072
    s_add_u32 s86, s83, 65536
    buffer_load_dwordx4 v20, s[32:35], s86 offen lds
    s_add_u32 m0, s91, 135168
    s_add_u32 s86, s83, 98304
    buffer_load_dwordx4 v20, s[32:35], s86 offen lds
    s_add_u32 m0, s91, 139264
    s_add_u32 s86, s83, 131072
    buffer_load_dwordx4 v20, s[32:35], s86 offen lds
    ds_read_b128 v[228:231], v232 offset:16
    s_waitcnt lgkmcnt(0)
    v_min3_u32 v228, v228, v229, v230
    v_min_u32 v228, v228, v231
    s_nop 0
    v_readfirstlane_b32 s64, v228
    s_cmp_ge_u32 s64, 10
    s_cbranch_scc1 L_free_1
    s_mov_b32 s68, 0
L_spin_2:
    ds_read_b128 v[228:231], v232 offset:16
    s_add_u32 s68, s68, 1
    s_waitcnt lgkmcnt(0)
    v_min3_u32 v228, v228, v229, v230
    v_min_u32 v228, v228, v231
    s_nop 0
    v_readfirstlane_b32 s64, v228
    s_cmp_ge_u32 s64, 10
    s_cbranch_scc1 L_spun_3
    s_cmp_lt_u32 s68, 1048576
    s_cbranch_scc1 L_spin_2
L_spun_3:
L_free_1:
    s_add_u32 m0, s91, 143360
    s_add_u32 s86, s83, 163840
    buffer_load_dwordx4 v20, s[32:35], s86 offen lds
    s_add_u32 m0, s91, 147456
    s_add_u32 s86, s83, 196608
    buffer_load_dwordx4 v20, s[32:35], s86 offen lds
    s_add_u32 m0, s91, 151552
    s_add_u32 s86, s83, 229376
    buffer_load_dwordx4 v20, s[32:35], s86 offen lds
    s_add_u32 m0, s91, 155648
    s_add_u32 s86, s83, 262144
    buffer_load_dwordx4 v20, s[32:35], s86 offen lds
    s_add_u32 m0, s91, 159744
    s_add_u32 s86, s83, 294912
    buffer_load_dwordx4 v20, s[32:35], s86 offen lds
    s_add_u32 m0, s91, 0
    s_add_u32 s86, s84, 0
    buffer_load_dwordx4 v20, s[32:35], s86 offen lds
    s_add_u32 m0, s91, 4096
    s_add_u32 s86, s84, 32768
    buffer_load_dwordx4 v20, s[32:35], s86 offen lds
    s_add_u32 m0, s91, 8192
    s_add_u32 s86, s84, 65536
    buffer_load_dwordx4 v20, s[32:35], s86 offen lds
    s_add_u32 m0, s91, 12288
    s_add_u32 s86, s84, 98304
    buffer_load_dwordx4 v20, s[32:35], s86 offen lds
    s_add_u32 m0, s91, 16384
    s_add_u32 s86, s84, 131072
    buffer_load_dwordx4 v20, s[32:35], s86 offen lds
    s_add_u32 m0, s91, 20480
    s_add_u32 s86, s84, 163840
    buffer_load_dwordx4 v20, s[32:35], s86 offen lds
    s_add_u32 m0, s91, 24576
    s_add_u32 s86, s84, 196608
    buffer_load_dwordx4 v20, s[32:35], s86 offen lds
    s_add_u32 m0, s91, 28672
    s_add_u32 s86, s84, 229376
    buffer_load_dwordx4 v20, s[32:35], s86 offen lds
    s_add_u32 m0, s91, 32768
    s_add_u32 s86, s84, 262144
    buffer_load_dwordx4 v20, s[32:35], s86 offen lds
    s_add_u32 m0, s91, 36864
    s_add_u32 s86, s84, 294912
    buffer_load_dwordx4 v20, s[32:35], s86 offen lds
    s_cmp_lg_u32 s67, 0
    s_cbranch_scc1 L_nopoll
    s_mul_i32 s61, s59, 4096
    s_add_u32 s61, s61, 6291456
    v_mul_u32_u24 v5, 128, v0
    v_mov_b32 v6, 1
    s_mov_b32 s68, 0
    s_mov_b64 exec, 0xffffffff
L_poll:
    buffer_load_dwordx2 v[24:25], v5, s[44:47], s61 offen sc1
    s_add_u32 s68, s68, 1
    s_waitcnt vmcnt(0)
    v_readfirstlane_b32 s62, v28
    v_cmp_ne_u64 vcc, v[24:25], v[28:29]
    s_cmp_ge_u32 s68, 1048576
    s_cbranch_scc1 L_polldone
    s_cmp_eq_u32 s62, 0
    s_cbranch_scc1 L_renonce
    s_cbranch_vccz L_polldone
    s_and_b32 s62, vcc_lo, 0x7fff
    s_cbranch_scc1 L_poll1
    s_mov_b64 exec, 1
    ds_write_b32 v232, v6 offset:32
    s_mov_b64 exec, 0xffffffff
L_poll1:
    s_and_b32 s62, vcc_lo, 0xffff8000
    s_cbranch_scc1 L_poll
    s_mov_b64 exec, 1
    ds_write_b32 v232, v6 offset:36
    s_mov_b64 exec, 0xffffffff
    s_branch L_poll
L_renonce:
    buffer_load_dwordx2 v[28:29], off, s[40:43], 0 sc1
    s_branch L_poll
L_polldone:
    s_mov_b64 exec, 1
    ds_write2_b32 v232, v6, v6 offset0:8 offset1:9
    s_mov_b64 exec, -1
L_nopoll:
    s_waitcnt vmcnt(0)
    v_mov_b32 v234, 10
    s_mov_b64 exec, 1
    ds_write_b32 v233, v234
    s_mov_b64 exec, -1
    s_endpgm
L_compute:
    s_waitcnt lgkmcnt(0)
    v_and_b32 v0, 63, v0
    s_lshr_b32 s61, s2, 6
    s_lshr_b32 s52, s2, 3
    s_add_u32 s62, s61, s52
    s_and_b32 s62, s62, 3
    s_bfe_u32 s67, s50, 0x20006
    s_and_b32 s61, s2, 3
    s_lshl2_add_u32 s54, s61, s62
    s_mul_i32 s56, s61, 22
    s_mul_i32 s63, s62, 6
    s_add_u32 s56, s56, s63
    s_min_u32 s56, s56, 82
    s_bitcmp1_b32 0xc888, s54
    s_cselect_b32 s57, 4, 6
    s_lshr_b32 s53, s2, 7
    s_and_b32 s61, s2, 4
    s_lshl3_add_u32 s55, s53, s61
    s_bfe_u32 s61, s2, 0x20005
    s_add_u32 s55, s55, s61
    v_mov_b32 v232, 81856
    s_lshl2_add_u32 s61, s67, 81872
    v_mov_b32 v233, s61
    s_lshr_b32 s53, s2, 7
    s_and_b32 s63, s2, 7
    s_lshl3_add_u32 s58, s53, s63
    s_bfe_u32 s63, s2, 0x10006
    s_lshl1_add_u32 s59, s58, s63
    s_bfe_u32 s60, s2, 0x30003
    s_mov_b32 s66, 0
    s_and_b32 s69, s67, 1
    s_lshr_b32 s70, s67, 1
    v_and_b32 v248, 15, v0
    v_lshrrev_b32 v249, 4, v0
    v_bfe_u32 v250, v0, 1, 3
    v_xor_b32 v250, v250, v249
    s_lshl_b32 s61, s69, 13
    v_lshlrev_b32 v248, 7, v248
    v_add_u32 v248, s61, v248
    v_lshl_add_u32 v240, v250, 4, v248
    v_xor_b32 v241, 64, v240
    v_bfe_u32 v248, v0, 2, 2
    s_bfe_u32 s61, s56, 0x10001
    v_xor_b32 v248, s61, v248
    v_lshl_add_u32 v248, v249, 3, v248
    v_mul_u32_u24 v248, 192, v248
    v_and_b32 v250, 3, v0
    v_lshl_add_u32 v248, v250, 3, v248
    s_mul_i32 s61, s70, 96
    s_add_u32 s61, s61, 16384
    v_add_u32 v248, s61, v248
    v_bfe_u32 v250, v0, 4, 1
    s_cmp_eq_u32 s70, 0
    s_cselect_b32 s61, 32, -32
    v_mul_lo_u32 v251, v250, s61
    v_add_u32 v244, v248, v251
    v_sub_u32 v245, v248, v251
    v_lshrrev_b32 v249, 5, v0
    v_lshlrev_b32 v246, 4, v0
    v_bfe_u32 v248, v0, 2, 2
    v_lshl_add_u32 v248, v249, 3, v248
    v_lshlrev_b32 v248, 7, v248
    v_bfe_u32 v250, v0, 4, 1
    v_lshl_add_u32 v248, v250, 5, v248
    v_and_b32 v250, 3, v0
    v_lshl_add_u32 v248, v250, 3, v248
    v_bfe_u32 v250, v0, 3, 1
    v_lshl_add_u32 v247, v250, 6, v248
    v_lshrrev_b32 v236, 3, v0
    v_lshlrev_b32 v236, 10, v236
    v_and_b32 v248, 7, v0
    v_lshl_add_u32 v236, v248, 4, v236
    v_xor_b32 v250, v248, v249
    v_and_b32 v251, 31, v0
    v_lshlrev_b32 v251, 8, v251
    v_lshl_add_u32 v224, v250, 4, v251
    v_lshrrev_b32 v250, 3, v0
    v_lshlrev_b32 v248, 1, v248
    v_xor_b32 v248, v248, v250
    v_lshlrev_b32 v250, 8, v250
    v_lshl_add_u32 v235, v248, 4, v250
    s_lshl_b32 s61, s70, 14
    s_lshl_b32 s77, s59, 1
    s_add_u32 s77, s77, s69
    s_mul_i32 s75, s77, 86
    s_lshl_b32 s77, s77, 15
    s_lshl_b32 s62, s60, 7
    s_add_u32 s77, s77, s62
    s_add_u32 s77, s77, s61
    s_mul_i32 s62, s70, 43
    s_add_u32 s75, s75, s62
    s_cmp_eq_u32 0, 0
    s_cselect_b32 s78, 23, 0
    s_add_u32 s78, s78, s75
    s_lshl_b32 s78, s78, 10
    s_mul_i32 s62, 0, 20
    s_add_u32 s75, s75, s62
    s_lshl_b32 s75, s75, 10
    s_lshl_b32 s72, s55, 1
    s_add_u32 s72, s72, s69
    s_mul_i32 s76, s72, 4096
    s_lshl_b32 s64, s54, 1
    s_add_u32 s64, s64, s70
    s_mul_i32 s64, s64, 128
    s_add_u32 s76, s76, s64
    s_add_u32 s76, s76, 6291456
    s_mul_i32 s72, s72, 172
    s_add_u32 s72, s72, s56
    s_mul_i32 s62, s70, 3
    s_add_u32 s72, s72, s62
    s_lshl_b32 s72, s72, 10
    s_add_u32 s73, s72, 88064
    s_sub_u32 s74, s57, s62
    s_mov_b32 s82, 0xbfb8aa3b
    s_mov_b32 s83, 0xbfb8aa3b
    s_lshl_b32 s61, s70, 13
    v_add_u32 v248, s61, v247
    v_xor_b32 v249, 64, v248
    s_mov_b64 s[44:45], s[16:17]
    s_mov_b32 s46, 6422528
    s_mov_b32 s47, 0x20000
    s_mov_b64 s[36:37], s[12:13]
    s_mov_b32 s38, 2097152
    s_mov_b32 s39, 0x20000
    s_mov_b64 s[40:41], s[14:15]
    s_mov_b32 s42, 256
    s_mov_b32 s43, 0x20000
    s_or_b32 s61, s2, s67
    s_cbranch_scc1 L_nopub
    s_memrealtime s[84:85]
    s_waitcnt lgkmcnt(0)
    s_or_b32 s84, s84, 1
    v_mov_b32 v2, s84
    v_mov_b32 v3, s85
    s_mov_b64 exec, 1
    buffer_store_dwordx2 v[2:3], off, s[40:43], 0 sc1
    s_mov_b64 exec, -1
    s_nop 1
L_nopub:
    v_mov_b64 v[0:1], 0
    v_mov_b64 v[2:3], 0
    v_mov_b64 v[4:5], 0
    v_mov_b64 v[6:7], 0
    v_mov_b64 v[8:9], 0
    v_mov_b64 v[10:11], 0
    v_mov_b64 v[12:13], 0
    v_mov_b64 v[14:15], 0
    v_mov_b64 v[16:17], 0
    v_mov_b64 v[18:19], 0
    v_mov_b64 v[20:21], 0
    v_mov_b64 v[22:23], 0
    v_mov_b64 v[24:25], 0
    v_mov_b64 v[26:27], 0
    v_mov_b64 v[28:29], 0
    v_mov_b64 v[30:31], 0
    v_mov_b64 v[32:33], 0
    v_mov_b64 v[34:35], 0
    v_mov_b64 v[36:37], 0
    v_mov_b64 v[38:39], 0
    v_mov_b64 v[40:41], 0
    v_mov_b64 v[42:43], 0
    v_mov_b64 v[44:45], 0
    v_mov_b64 v[46:47], 0
    v_mov_b64 v[48:49], 0
    v_mov_b64 v[50:51], 0
    v_mov_b64 v[52:53], 0
    v_mov_b64 v[54:55], 0
    v_mov_b64 v[56:57], 0
    v_mov_b64 v[58:59], 0
    v_mov_b64 v[60:61], 0
    v_mov_b64 v[62:63], 0
    v_mov_b64 v[64:65], 0
    v_mov_b64 v[66:67], 0
    v_mov_b64 v[68:69], 0
    v_mov_b64 v[70:71], 0
    v_mov_b64 v[72:73], 0
    v_mov_b64 v[74:75], 0
    v_mov_b64 v[76:77], 0
    v_mov_b64 v[78:79], 0
    v_mov_b64 v[80:81], 0
    v_mov_b64 v[82:83], 0
    v_mov_b64 v[84:85], 0
    v_mov_b64 v[86:87], 0
    v_mov_b64 v[88:89], 0
    v_mov_b64 v[90:91], 0
    v_mov_b64 v[92:93], 0
    v_mov_b64 v[94:95], 0
    v_lshrrev_b32 v228, 1, v246
    s_mov_b64 exec, 0xffff
    buffer_store_dwordx2 v[0:1], v228, s[44:47], s76 offen sc1
    s_mov_b64 exec, -1
    s_mov_b32 s65, 0
    s_mov_b32 s71, 0
    s_barrier
    ds_read_b128 v[96:99], v240 offset:0
    ds_read_b64_tr_b16 v[112:113], v244 offset:0
    ds_read_b64_tr_b16 v[114:115], v244 offset:768
    ds_read_b128 v[100:103], v240 offset:2048
    ds_read_b64_tr_b16 v[116:117], v244 offset:12288
    ds_read_b64_tr_b16 v[118:119], v244 offset:13056
    ds_read_b128 v[104:107], v240 offset:4096
    ds_read_b128 v[108:111], v240 offset:6144
    ds_read_b64_tr_b16 v[120:121], v245 offset:32
    ds_read_b64_tr_b16 v[122:123], v245 offset:800
    ds_read_b64_tr_b16 v[124:125], v245 offset:12320
    ds_read_b64_tr_b16 v[126:127], v245 offset:13088
    s_waitcnt lgkmcnt(8)
    ds_read_b64_tr_b16 v[128:129], v244 offset:64
    ds_read_b64_tr_b16 v[130:131], v244 offset:832
    ds_read_b64_tr_b16 v[132:133], v244 offset:12352
    ds_read_b64_tr_b16 v[134:135], v244 offset:13120
    s_cmp_lt_u32 s74, 2
    s_cbranch_scc1 L_q1
L_p1:
    s_waitcnt lgkmcnt(0)
    v_mfma_f32_16x16x32_bf16 v[0:3], v[112:115], v[96:99], v[0:3]
    ds_read_b128 v[136:139], v241 offset:0
    v_mfma_f32_16x16x32_bf16 v[4:7], v[112:115], v[100:103], v[4:7]
    ds_read_b64_tr_b16 v[152:153], v244 offset:6144
    v_mfma_f32_16x16x32_bf16 v[8:11], v[116:119], v[96:99], v[8:11]
    ds_read_b64_tr_b16 v[154:155], v244 offset:6912
    v_mfma_f32_16x16x32_bf16 v[12:15], v[116:119], v[100:103], v[12:15]
    ds_read_b128 v[140:143], v241 offset:2048
    v_mfma_f32_16x16x32_bf16 v[48:51], v[112:115], v[104:107], v[48:51]
    ds_read_b64_tr_b16 v[156:157], v244 offset:18432
    v_mfma_f32_16x16x32_bf16 v[52:55], v[112:115], v[108:111], v[52:55]
    ds_read_b64_tr_b16 v[158:159], v244 offset:19200
    v_mfma_f32_16x16x32_bf16 v[56:59], v[116:119], v[104:107], v[56:59]
    ds_read_b128 v[144:147], v241 offset:4096
    v_mfma_f32_16x16x32_bf16 v[60:63], v[116:119], v[108:111], v[60:63]
    ds_read_b128 v[148:151], v241 offset:6144
    v_mfma_f32_16x16x32_bf16 v[16:19], v[120:123], v[96:99], v[16:19]
    ds_read_b64_tr_b16 v[160:161], v245 offset:6176
    v_mfma_f32_16x16x32_bf16 v[20:23], v[120:123], v[100:103], v[20:23]
    ds_read_b64_tr_b16 v[162:163], v245 offset:6944
    v_mfma_f32_16x16x32_bf16 v[24:27], v[124:127], v[96:99], v[24:27]
    ds_read_b64_tr_b16 v[164:165], v245 offset:18464
    v_mfma_f32_16x16x32_bf16 v[28:31], v[124:127], v[100:103], v[28:31]
    ds_read_b64_tr_b16 v[166:167], v245 offset:19232
    v_mfma_f32_16x16x32_bf16 v[64:67], v[120:123], v[104:107], v[64:67]
    ds_read_b64_tr_b16 v[168:169], v244 offset:6208
    v_mfma_f32_16x16x32_bf16 v[68:71], v[120:123], v[108:111], v[68:71]
    ds_read_b64_tr_b16 v[170:171], v244 offset:6976
    v_mfma_f32_16x16x32_bf16 v[72:75], v[124:127], v[104:107], v[72:75]
    ds_read_b64_tr_b16 v[172:173], v244 offset:18496
    v_mfma_f32_16x16x32_bf16 v[76:79], v[124:127], v[108:111], v[76:79]
    ds_read_b64_tr_b16 v[174:175], v244 offset:19264
    v_mfma_f32_16x16x32_bf16 v[32:35], v[128:131], v[96:99], v[32:35]
    v_mfma_f32_16x16x32_bf16 v[36:39], v[128:131], v[100:103], v[36:39]
    v_mfma_f32_16x16x32_bf16 v[40:43], v[132:135], v[96:99], v[40:43]
    v_mfma_f32_16x16x32_bf16 v[44:47], v[132:135], v[100:103], v[44:47]
    v_mfma_f32_16x16x32_bf16 v[80:83], v[128:131], v[104:107], v[80:83]
    v_mfma_f32_16x16x32_bf16 v[84:87], v[128:131], v[108:111], v[84:87]
    v_mfma_f32_16x16x32_bf16 v[88:91], v[132:135], v[104:107], v[88:91]
    v_mfma_f32_16x16x32_bf16 v[92:95], v[132:135], v[108:111], v[92:95]
    s_waitcnt lgkmcnt(0)
    v_mfma_f32_16x16x32_bf16 v[0:3], v[152:155], v[136:139], v[0:3]
    s_add_u32 s65, s65, 1
    s_and_b32 s71, s65, 3
    v_mfma_f32_16x16x32_bf16 v[4:7], v[152:155], v[140:143], v[4:7]
    s_mov_b32 s61, 4294844416
    s_cmov_b32 s61, 40960
    v_mfma_f32_16x16x32_bf16 v[8:11], v[156:159], v[136:139], v[8:11]
    v_add_u32 v240, s61, v240
    v_add_u32 v244, s61, v244
    v_mfma_f32_16x16x32_bf16 v[12:15], v[156:159], v[140:143], v[12:15]
    v_add_u32 v245, s61, v245
    v_mfma_f32_16x16x32_bf16 v[48:51], v[152:155], v[144:147], v[48:51]
    v_mfma_f32_16x16x32_bf16 v[52:55], v[152:155], v[148:151], v[52:55]
    s_barrier
    ds_read_b128 v[96:99], v240 offset:0
    v_mfma_f32_16x16x32_bf16 v[56:59], v[156:159], v[144:147], v[56:59]
    ds_read_b64_tr_b16 v[112:113], v244 offset:0
    v_mfma_f32_16x16x32_bf16 v[60:63], v[156:159], v[148:151], v[60:63]
    ds_read_b64_tr_b16 v[114:115], v244 offset:768
    v_mfma_f32_16x16x32_bf16 v[16:19], v[160:163], v[136:139], v[16:19]
    ds_read_b128 v[100:103], v240 offset:2048
    v_mfma_f32_16x16x32_bf16 v[20:23], v[160:163], v[140:143], v[20:23]
    ds_read_b64_tr_b16 v[116:117], v244 offset:12288
    v_mfma_f32_16x16x32_bf16 v[24:27], v[164:167], v[136:139], v[24:27]
    ds_read_b64_tr_b16 v[118:119], v244 offset:13056
    v_mfma_f32_16x16x32_bf16 v[28:31], v[164:167], v[140:143], v[28:31]
    ds_read_b128 v[104:107], v240 offset:4096
    v_mfma_f32_16x16x32_bf16 v[64:67], v[160:163], v[144:147], v[64:67]
    ds_read_b128 v[108:111], v240 offset:6144
    v_mfma_f32_16x16x32_bf16 v[68:71], v[160:163], v[148:151], v[68:71]
    ds_read_b64_tr_b16 v[120:121], v245 offset:32
    v_mfma_f32_16x16x32_bf16 v[72:75], v[164:167], v[144:147], v[72:75]
    ds_read_b64_tr_b16 v[122:123], v245 offset:800
    v_mfma_f32_16x16x32_bf16 v[76:79], v[164:167], v[148:151], v[76:79]
    ds_read_b64_tr_b16 v[124:125], v245 offset:12320
    v_mfma_f32_16x16x32_bf16 v[32:35], v[168:171], v[136:139], v[32:35]
    ds_read_b64_tr_b16 v[126:127], v245 offset:13088
    v_mfma_f32_16x16x32_bf16 v[36:39], v[168:171], v[140:143], v[36:39]
    ds_read_b64_tr_b16 v[128:129], v244 offset:64
    v_mfma_f32_16x16x32_bf16 v[40:43], v[172:175], v[136:139], v[40:43]
    ds_read_b64_tr_b16 v[130:131], v244 offset:832
    v_mfma_f32_16x16x32_bf16 v[44:47], v[172:175], v[140:143], v[44:47]
    ds_read_b64_tr_b16 v[132:133], v244 offset:12352
    v_mfma_f32_16x16x32_bf16 v[80:83], v[168:171], v[144:147], v[80:83]
    ds_read_b64_tr_b16 v[134:135], v244 offset:13120
    v_mfma_f32_16x16x32_bf16 v[84:87], v[168:171], v[148:151], v[84:87]
    v_add_u32 v241, s61, v241
    v_mfma_f32_16x16x32_bf16 v[88:91], v[172:175], v[144:147], v[88:91]
    s_bitcmp1_b32 64, s65
    s_cbranch_scc1 L_p1_x
L_p1_back:
    s_cmp_lt_u32 s65, 7
    v_mfma_f32_16x16x32_bf16 v[92:95], v[172:175], v[148:151], v[92:95]
    s_cbranch_scc1 L_p1
    s_branch L_p1_done
L_p1_x:
    buffer_load_dwordx2 v[254:255], off, s[40:43], 0 sc1
    s_lshl_b32 s62, s67, 4
    v_mov_b64 v[228:229], 0
    v_mov_b64 v[230:231], 0
    v_add_u32 v234, s62, v232
    s_mov_b64 exec, 1
    ds_write_b128 v234, v[228:231]
    s_mov_b64 exec, -1
    s_branch L_p1_back
L_q1:
    s_waitcnt lgkmcnt(0)
    v_mfma_f32_16x16x32_bf16 v[0:3], v[112:115], v[96:99], v[0:3]
    ds_read_b128 v[136:139], v241 offset:0
    v_mfma_f32_16x16x32_bf16 v[4:7], v[112:115], v[100:103], v[4:7]
    ds_read_b64_tr_b16 v[152:153], v244 offset:6144
    v_mfma_f32_16x16x32_bf16 v[8:11], v[116:119], v[96:99], v[8:11]
    ds_read_b64_tr_b16 v[154:155], v244 offset:6912
    v_mfma_f32_16x16x32_bf16 v[12:15], v[116:119], v[100:103], v[12:15]
    ds_read_b128 v[140:143], v241 offset:2048
    v_mfma_f32_16x16x32_bf16 v[48:51], v[112:115], v[104:107], v[48:51]
    ds_read_b64_tr_b16 v[156:157], v244 offset:18432
    v_mfma_f32_16x16x32_bf16 v[52:55], v[112:115], v[108:111], v[52:55]
    ds_read_b64_tr_b16 v[158:159], v244 offset:19200
    v_mfma_f32_16x16x32_bf16 v[56:59], v[116:119], v[104:107], v[56:59]
    ds_read_b128 v[144:147], v241 offset:4096
    v_mfma_f32_16x16x32_bf16 v[60:63], v[116:119], v[108:111], v[60:63]
    ds_read_b128 v[148:151], v241 offset:6144
    s_waitcnt lgkmcnt(0)
    s_add_u32 s65, s65, 1
    s_and_b32 s71, s65, 3
    s_mov_b32 s61, 4294844416
    s_cmov_b32 s61, 40960
    v_add_u32 v240, s61, v240
    v_add_u32 v241, s61, v241
    v_add_u32 v244, s61, v244
    v_add_u32 v245, s61, v245
    s_barrier
    v_mfma_f32_16x16x32_bf16 v[0:3], v[152:155], v[136:139], v[0:3]
    ds_read_b128 v[96:99], v240 offset:0
    v_mfma_f32_16x16x32_bf16 v[4:7], v[152:155], v[140:143], v[4:7]
    ds_read_b64_tr_b16 v[112:113], v244 offset:0
    v_mfma_f32_16x16x32_bf16 v[8:11], v[156:159], v[136:139], v[8:11]
    ds_read_b64_tr_b16 v[114:115], v244 offset:768
    v_mfma_f32_16x16x32_bf16 v[12:15], v[156:159], v[140:143], v[12:15]
    ds_read_b128 v[100:103], v240 offset:2048
    v_mfma_f32_16x16x32_bf16 v[48:51], v[152:155], v[144:147], v[48:51]
    ds_read_b64_tr_b16 v[116:117], v244 offset:12288
    v_mfma_f32_16x16x32_bf16 v[52:55], v[152:155], v[148:151], v[52:55]
    ds_read_b64_tr_b16 v[118:119], v244 offset:13056
    v_mfma_f32_16x16x32_bf16 v[56:59], v[156:159], v[144:147], v[56:59]
    ds_read_b128 v[104:107], v240 offset:4096
    v_mfma_f32_16x16x32_bf16 v[60:63], v[156:159], v[148:151], v[60:63]
    ds_read_b128 v[108:111], v240 offset:6144
    s_bitcmp1_b32 64, s65
    s_cbranch_scc1 L_q1_x
L_q1_back:
    s_cmp_lt_u32 s65, 7
    s_cbranch_scc1 L_q1
    s_branch L_p1_done
L_q1_x:
    buffer_load_dwordx2 v[254:255], off, s[40:43], 0 sc1
    s_lshl_b32 s62, s67, 4
    v_mov_b64 v[228:229], 0
    v_mov_b64 v[230:231], 0
    v_add_u32 v234, s62, v232
    s_mov_b64 exec, 1
    ds_write_b128 v234, v[228:231]
    s_mov_b64 exec, -1
    s_branch L_q1_back
L_p1_done:
    s_waitcnt lgkmcnt(0)
    v_mfma_f32_16x16x32_bf16 v[0:3], v[112:115], v[96:99], v[0:3]
    ds_read_b128 v[136:139], v241 offset:0
    ds_read_b64_tr_b16 v[152:153], v244 offset:6144
    v_mfma_f32_16x16x32_bf16 v[4:7], v[112:115], v[100:103], v[4:7]
    ds_read_b64_tr_b16 v[154:155], v244 offset:6912
    ds_read_b128 v[140:143], v241 offset:2048
    v_mfma_f32_16x16x32_bf16 v[8:11], v[116:119], v[96:99], v[8:11]
    ds_read_b64_tr_b16 v[156:157], v244 offset:18432
    ds_read_b64_tr_b16 v[158:159], v244 offset:19200
    v_mfma_f32_16x16x32_bf16 v[12:15], v[116:119], v[100:103], v[12:15]
    ds_read_b128 v[144:147], v241 offset:4096
    ds_read_b128 v[148:151], v241 offset:6144
    v_mfma_f32_16x16x32_bf16 v[48:51], v[112:115], v[104:107], v[48:51]
    s_waitcnt lgkmcnt(6)
    ds_read_b64_tr_b16 v[160:161], v245 offset:6176
    v_mfma_f32_16x16x32_bf16 v[52:55], v[112:115], v[108:111], v[52:55]
    ds_read_b64_tr_b16 v[162:163], v245 offset:6944
    ds_read_b64_tr_b16 v[164:165], v245 offset:18464
    v_mfma_f32_16x16x32_bf16 v[56:59], v[116:119], v[104:107], v[56:59]
    ds_read_b64_tr_b16 v[166:167], v245 offset:19232
    ds_read_b64_tr_b16 v[168:169], v244 offset:6208
    v_mfma_f32_16x16x32_bf16 v[60:63], v[116:119], v[108:111], v[60:63]
    ds_read_b64_tr_b16 v[170:171], v244 offset:6976
    ds_read_b64_tr_b16 v[172:173], v244 offset:18496
    v_mfma_f32_16x16x32_bf16 v[16:19], v[120:123], v[96:99], v[16:19]
    ds_read_b64_tr_b16 v[174:175], v244 offset:19264
    v_mfma_f32_16x16x32_bf16 v[20:23], v[120:123], v[100:103], v[20:23]
    v_mfma_f32_16x16x32_bf16 v[24:27], v[124:127], v[96:99], v[24:27]
    s_cmp_lt_u32 s74, 2
    s_cselect_b32 s79, 0x40000000, s72
    s_cselect_b32 s80, 0x40000000, s73
    v_mfma_f32_16x16x32_bf16 v[28:31], v[124:127], v[100:103], v[28:31]
    s_waitcnt lgkmcnt(4)
    v_mfma_f32_16x16x32_bf16 v[0:3], v[152:155], v[136:139], v[0:3]
    v_mfma_f32_16x16x32_bf16 v[4:7], v[152:155], v[140:143], v[4:7]
    v_mfma_f32_16x16x32_bf16 v[8:11], v[156:159], v[136:139], v[8:11]
    v_mfma_f32_16x16x32_bf16 v[12:15], v[156:159], v[140:143], v[12:15]
    s_nop 1
    s_waitcnt lgkmcnt(0)
    s_barrier
    v_mfma_f32_16x16x32_bf16 v[48:51], v[152:155], v[144:147], v[48:51]
    s_nop 1
    v_mfma_f32_16x16x32_bf16 v[52:55], v[152:155], v[148:151], v[52:55]
    v_pk_mul_f32 v[176:177], v[0:1], s[82:83]
    v_pk_mul_f32 v[178:179], v[2:3], s[82:83]
    v_pk_mul_f32 v[180:181], v[4:5], s[82:83]
    v_pk_mul_f32 v[182:183], v[6:7], s[82:83]
    v_exp_f32 v176, v176
    v_mfma_f32_16x16x32_bf16 v[56:59], v[156:159], v[144:147], v[56:59]
    v_exp_f32 v177, v177
    v_exp_f32 v178, v178
    v_exp_f32 v179, v179
    v_mfma_f32_16x16x32_bf16 v[60:63], v[156:159], v[148:151], v[60:63]
    v_exp_f32 v180, v180
    v_exp_f32 v181, v181
    v_exp_f32 v182, v182
    v_mfma_f32_16x16x32_bf16 v[64:67], v[120:123], v[104:107], v[64:67]
    v_exp_f32 v183, v183
    v_pk_add_f32 v[176:177], v[176:177], 1.0 op_sel_hi:[1,0]
    v_pk_add_f32 v[178:179], v[178:179], 1.0 op_sel_hi:[1,0]
    v_pk_add_f32 v[180:181], v[180:181], 1.0 op_sel_hi:[1,0]
    v_pk_add_f32 v[182:183], v[182:183], 1.0 op_sel_hi:[1,0]
    v_mfma_f32_16x16x32_bf16 v[68:71], v[120:123], v[108:111], v[68:71]
    v_rcp_f32 v176, v176
    v_rcp_f32 v177, v177
    v_rcp_f32 v178, v178
    v_mfma_f32_16x16x32_bf16 v[72:75], v[124:127], v[104:107], v[72:75]
    v_rcp_f32 v179, v179
    v_rcp_f32 v180, v180
    v_rcp_f32 v181, v181
    v_mfma_f32_16x16x32_bf16 v[76:79], v[124:127], v[108:111], v[76:79]
    v_rcp_f32 v182, v182
    v_rcp_f32 v183, v183
    v_pk_mul_f32 v[0:1], v[0:1], v[176:177]
    v_pk_mul_f32 v[2:3], v[2:3], v[178:179]
    v_mfma_f32_16x16x32_bf16 v[16:19], v[160:163], v[136:139], v[16:19]
    v_pk_mul_f32 v[4:5], v[4:5], v[180:181]
    v_pk_mul_f32 v[6:7], v[6:7], v[182:183]
    v_pk_mul_f32 v[0:1], v[0:1], v[8:9]
    v_pk_mul_f32 v[2:3], v[2:3], v[10:11]
    v_pk_mul_f32 v[4:5], v[4:5], v[12:13]
    v_pk_mul_f32 v[6:7], v[6:7], v[14:15]
    v_mfma_f32_16x16x32_bf16 v[20:23], v[160:163], v[140:143], v[20:23]
    v_cvt_pk_bf16_f32 v8, v0, v1
    v_cvt_pk_bf16_f32 v9, v2, v3
    v_cvt_pk_bf16_f32 v10, v4, v5
    v_cvt_pk_bf16_f32 v11, v6, v7
    v_pk_mul_f32 v[184:185], v[48:49], s[82:83]
    v_pk_mul_f32 v[186:187], v[50:51], s[82:83]
    v_mfma_f32_16x16x32_bf16 v[24:27], v[164:167], v[136:139], v[24:27]
    v_permlane16_swap_b32 v8, v10
    v_permlane16_swap_b32 v9, v11
    buffer_store_dwordx4 v[8:11], v246, s[44:47], s72 offen offset:0 sc1
    v_pk_mul_f32 v[188:189], v[52:53], s[82:83]
    v_pk_mul_f32 v[190:191], v[54:55], s[82:83]
    v_mfma_f32_16x16x32_bf16 v[28:31], v[164:167], v[140:143], v[28:31]
    v_exp_f32 v184, v184
    v_exp_f32 v185, v185
    v_exp_f32 v186, v186
    v_mfma_f32_16x16x32_bf16 v[64:67], v[160:163], v[144:147], v[64:67]
    v_exp_f32 v187, v187
    v_exp_f32 v188, v188
    v_exp_f32 v189, v189
    v_mfma_f32_16x16x32_bf16 v[68:71], v[160:163], v[148:151], v[68:71]
    v_exp_f32 v190, v190
    v_exp_f32 v191, v191
    v_pk_add_f32 v[184:185], v[184:185], 1.0 op_sel_hi:[1,0]
    v_pk_add_f32 v[186:187], v[186:187], 1.0 op_sel_hi:[1,0]
    v_mfma_f32_16x16x32_bf16 v[72:75], v[164:167], v[144:147], v[72:75]
    v_pk_add_f32 v[188:189], v[188:189], 1.0 op_sel_hi:[1,0]
    v_pk_add_f32 v[190:191], v[190:191], 1.0 op_sel_hi:[1,0]
    v_rcp_f32 v184, v184
    v_rcp_f32 v185, v185
    v_mfma_f32_16x16x32_bf16 v[76:79], v[164:167], v[148:151], v[76:79]
    v_rcp_f32 v186, v186
    v_rcp_f32 v187, v187
    v_rcp_f32 v188, v188
    v_mfma_f32_16x16x32_bf16 v[32:35], v[128:131], v[96:99], v[32:35]
    v_rcp_f32 v189, v189
    v_rcp_f32 v190, v190
    v_rcp_f32 v191, v191
    v_mfma_f32_16x16x32_bf16 v[36:39], v[128:131], v[100:103], v[36:39]
    v_pk_mul_f32 v[48:49], v[48:49], v[184:185]
    v_pk_mul_f32 v[50:51], v[50:51], v[186:187]
    v_pk_mul_f32 v[52:53], v[52:53], v[188:189]
    v_pk_mul_f32 v[54:55], v[54:55], v[190:191]
    v_pk_mul_f32 v[48:49], v[48:49], v[56:57]
    v_pk_mul_f32 v[50:51], v[50:51], v[58:59]
    v_mfma_f32_16x16x32_bf16 v[40:43], v[132:135], v[96:99], v[40:43]
    v_pk_mul_f32 v[52:53], v[52:53], v[60:61]
    v_pk_mul_f32 v[54:55], v[54:55], v[62:63]
    v_cvt_pk_bf16_f32 v56, v48, v49
    v_cvt_pk_bf16_f32 v57, v50, v51
    v_cvt_pk_bf16_f32 v58, v52, v53
    v_cvt_pk_bf16_f32 v59, v54, v55
    v_mfma_f32_16x16x32_bf16 v[44:47], v[132:135], v[100:103], v[44:47]
    v_pk_mul_f32 v[176:177], v[16:17], s[82:83]
    v_pk_mul_f32 v[178:179], v[18:19], s[82:83]
    v_permlane16_swap_b32 v56, v58
    v_permlane16_swap_b32 v57, v59
    buffer_store_dwordx4 v[56:59], v246, s[44:47], s73 offen offset:0 sc1
    v_mfma_f32_16x16x32_bf16 v[32:35], v[168:171], v[136:139], v[32:35]
    v_pk_mul_f32 v[180:181], v[20:21], s[82:83]
    v_pk_mul_f32 v[182:183], v[22:23], s[82:83]
    v_exp_f32 v176, v176
    v_exp_f32 v177, v177
    v_mfma_f32_16x16x32_bf16 v[36:39], v[168:171], v[140:143], v[36:39]
    v_exp_f32 v178, v178
    v_exp_f32 v179, v179
    v_exp_f32 v180, v180
    v_mfma_f32_16x16x32_bf16 v[40:43], v[172:175], v[136:139], v[40:43]
    v_exp_f32 v181, v181
    v_exp_f32 v182, v182
    v_exp_f32 v183, v183
    v_mfma_f32_16x16x32_bf16 v[44:47], v[172:175], v[140:143], v[44:47]
    v_pk_add_f32 v[176:177], v[176:177], 1.0 op_sel_hi:[1,0]
    v_pk_add_f32 v[178:179], v[178:179], 1.0 op_sel_hi:[1,0]
    v_pk_add_f32 v[180:181], v[180:181], 1.0 op_sel_hi:[1,0]
    v_pk_add_f32 v[182:183], v[182:183], 1.0 op_sel_hi:[1,0]
    v_rcp_f32 v176, v176
    v_mfma_f32_16x16x32_bf16 v[80:83], v[128:131], v[104:107], v[80:83]
    v_rcp_f32 v177, v177
    v_rcp_f32 v178, v178
    v_rcp_f32 v179, v179
    v_mfma_f32_16x16x32_bf16 v[84:87], v[128:131], v[108:111], v[84:87]
    v_rcp_f32 v180, v180
    v_rcp_f32 v181, v181
    v_rcp_f32 v182, v182
    v_mfma_f32_16x16x32_bf16 v[88:91], v[132:135], v[104:107], v[88:91]
    v_rcp_f32 v183, v183
    v_pk_mul_f32 v[16:17], v[16:17], v[176:177]
    v_pk_mul_f32 v[18:19], v[18:19], v[178:179]
    v_pk_mul_f32 v[20:21], v[20:21], v[180:181]
    v_pk_mul_f32 v[22:23], v[22:23], v[182:183]
    v_mfma_f32_16x16x32_bf16 v[92:95], v[132:135], v[108:111], v[92:95]
    v_pk_mul_f32 v[16:17], v[16:17], v[24:25]
    v_pk_mul_f32 v[18:19], v[18:19], v[26:27]
    v_pk_mul_f32 v[20:21], v[20:21], v[28:29]
    v_pk_mul_f32 v[22:23], v[22:23], v[30:31]
    v_cvt_pk_bf16_f32 v24, v16, v17
    v_cvt_pk_bf16_f32 v25, v18, v19
    v_mfma_f32_16x16x32_bf16 v[80:83], v[168:171], v[144:147], v[80:83]
    v_cvt_pk_bf16_f32 v26, v20, v21
    v_cvt_pk_bf16_f32 v27, v22, v23
    v_pk_mul_f32 v[184:185], v[64:65], s[82:83]
    v_pk_mul_f32 v[186:187], v[66:67], s[82:83]
    v_permlane16_swap_b32 v24, v26
    v_permlane16_swap_b32 v25, v27
    v_mfma_f32_16x16x32_bf16 v[84:87], v[168:171], v[148:151], v[84:87]
    buffer_store_dwordx4 v[24:27], v246, s[44:47], s79 offen offset:1024 sc1
    v_pk_mul_f32 v[188:189], v[68:69], s[82:83]
    v_pk_mul_f32 v[190:191], v[70:71], s[82:83]
    v_exp_f32 v184, v184
    v_mfma_f32_16x16x32_bf16 v[88:91], v[172:175], v[144:147], v[88:91]
    v_exp_f32 v185, v185
    v_exp_f32 v186, v186
    v_exp_f32 v187, v187
    v_mfma_f32_16x16x32_bf16 v[92:95], v[172:175], v[148:151], v[92:95]
    s_cmp_lt_u32 s74, 2
    s_cbranch_scc1 L_epi_done
    v_exp_f32 v188, v188
    v_exp_f32 v189, v189
    v_exp_f32 v190, v190
    v_exp_f32 v191, v191
    v_pk_add_f32 v[184:185], v[184:185], 1.0 op_sel_hi:[1,0]
    v_pk_add_f32 v[186:187], v[186:187], 1.0 op_sel_hi:[1,0]
    v_pk_add_f32 v[188:189], v[188:189], 1.0 op_sel_hi:[1,0]
    v_pk_add_f32 v[190:191], v[190:191], 1.0 op_sel_hi:[1,0]
    v_rcp_f32 v184, v184
    v_rcp_f32 v185, v185
    v_rcp_f32 v186, v186
    v_rcp_f32 v187, v187
    v_rcp_f32 v188, v188
    v_rcp_f32 v189, v189
    v_rcp_f32 v190, v190
    v_rcp_f32 v191, v191
    v_pk_mul_f32 v[64:65], v[64:65], v[184:185]
    v_pk_mul_f32 v[66:67], v[66:67], v[186:187]
    v_pk_mul_f32 v[68:69], v[68:69], v[188:189]
    v_pk_mul_f32 v[70:71], v[70:71], v[190:191]
    v_pk_mul_f32 v[64:65], v[64:65], v[72:73]
    v_pk_mul_f32 v[66:67], v[66:67], v[74:75]
    v_pk_mul_f32 v[68:69], v[68:69], v[76:77]
    v_pk_mul_f32 v[70:71], v[70:71], v[78:79]
    v_cvt_pk_bf16_f32 v72, v64, v65
    v_cvt_pk_bf16_f32 v73, v66, v67
    v_cvt_pk_bf16_f32 v74, v68, v69
    v_cvt_pk_bf16_f32 v75, v70, v71
    v_pk_mul_f32 v[176:177], v[32:33], s[82:83]
    v_pk_mul_f32 v[178:179], v[34:35], s[82:83]
    v_permlane16_swap_b32 v72, v74
    v_permlane16_swap_b32 v73, v75
    buffer_store_dwordx4 v[72:75], v246, s[44:47], s80 offen offset:1024 sc1
    v_pk_mul_f32 v[180:181], v[36:37], s[82:83]
    v_pk_mul_f32 v[182:183], v[38:39], s[82:83]
    v_exp_f32 v176, v176
    v_exp_f32 v177, v177
    v_exp_f32 v178, v178
    v_exp_f32 v179, v179
    v_exp_f32 v180, v180
    v_exp_f32 v181, v181
    v_exp_f32 v182, v182
    v_exp_f32 v183, v183
    v_pk_add_f32 v[176:177], v[176:177], 1.0 op_sel_hi:[1,0]
    v_pk_add_f32 v[178:179], v[178:179], 1.0 op_sel_hi:[1,0]
    v_pk_add_f32 v[180:181], v[180:181], 1.0 op_sel_hi:[1,0]
    v_pk_add_f32 v[182:183], v[182:183], 1.0 op_sel_hi:[1,0]
    v_rcp_f32 v176, v176
    v_rcp_f32 v177, v177
    v_rcp_f32 v178, v178
    v_rcp_f32 v179, v179
    v_rcp_f32 v180, v180
    v_rcp_f32 v181, v181
    v_rcp_f32 v182, v182
    v_rcp_f32 v183, v183
    v_pk_mul_f32 v[32:33], v[32:33], v[176:177]
    v_pk_mul_f32 v[34:35], v[34:35], v[178:179]
    v_pk_mul_f32 v[36:37], v[36:37], v[180:181]
    v_pk_mul_f32 v[38:39], v[38:39], v[182:183]
    v_pk_mul_f32 v[32:33], v[32:33], v[40:41]
    v_pk_mul_f32 v[34:35], v[34:35], v[42:43]
    v_pk_mul_f32 v[36:37], v[36:37], v[44:45]
    v_pk_mul_f32 v[38:39], v[38:39], v[46:47]
    v_cvt_pk_bf16_f32 v40, v32, v33
    v_cvt_pk_bf16_f32 v41, v34, v35
    v_cvt_pk_bf16_f32 v42, v36, v37
    v_cvt_pk_bf16_f32 v43, v38, v39
    v_pk_mul_f32 v[184:185], v[80:81], s[82:83]
    v_pk_mul_f32 v[186:187], v[82:83], s[82:83]
    v_permlane16_swap_b32 v40, v42
    v_permlane16_swap_b32 v41, v43
    buffer_store_dwordx4 v[40:43], v246, s[44:47], s79 offen offset:2048 sc1
    v_pk_mul_f32 v[188:189], v[84:85], s[82:83]
    v_pk_mul_f32 v[190:191], v[86:87], s[82:83]
    v_exp_f32 v184, v184
    v_exp_f32 v185, v185
    v_exp_f32 v186, v186
    v_exp_f32 v187, v187
    v_exp_f32 v188, v188
    v_exp_f32 v189, v189
    v_exp_f32 v190, v190
    v_exp_f32 v191, v191
    v_pk_add_f32 v[184:185], v[184:185], 1.0 op_sel_hi:[1,0]
    v_pk_add_f32 v[186:187], v[186:187], 1.0 op_sel_hi:[1,0]
    v_pk_add_f32 v[188:189], v[188:189], 1.0 op_sel_hi:[1,0]
    v_pk_add_f32 v[190:191], v[190:191], 1.0 op_sel_hi:[1,0]
    v_rcp_f32 v184, v184
    v_rcp_f32 v185, v185
    v_rcp_f32 v186, v186
    v_rcp_f32 v187, v187
    v_rcp_f32 v188, v188
    v_rcp_f32 v189, v189
    v_rcp_f32 v190, v190
    v_rcp_f32 v191, v191
    v_pk_mul_f32 v[80:81], v[80:81], v[184:185]
    v_pk_mul_f32 v[82:83], v[82:83], v[186:187]
    v_pk_mul_f32 v[84:85], v[84:85], v[188:189]
    v_pk_mul_f32 v[86:87], v[86:87], v[190:191]
    v_pk_mul_f32 v[80:81], v[80:81], v[88:89]
    v_pk_mul_f32 v[82:83], v[82:83], v[90:91]
    v_pk_mul_f32 v[84:85], v[84:85], v[92:93]
    v_pk_mul_f32 v[86:87], v[86:87], v[94:95]
    v_cvt_pk_bf16_f32 v88, v80, v81
    v_cvt_pk_bf16_f32 v89, v82, v83
    v_cvt_pk_bf16_f32 v90, v84, v85
    v_cvt_pk_bf16_f32 v91, v86, v87
    s_nop 1
    v_permlane16_swap_b32 v88, v90
    v_permlane16_swap_b32 v89, v91
    buffer_store_dwordx4 v[88:91], v246, s[44:47], s80 offen offset:2048 sc1
L_epi_done:
    v_mov_b32 v234, 9
    s_mov_b64 exec, 1
    ds_write_b32 v233, v234
    s_mov_b64 exec, -1
    s_cmp_eq_u32 s70, s66
    s_mov_b32 s61, 81920
    s_cmov_b32 s61, 40960
    s_mov_b32 s62, 40960
    s_cmov_b32 s62, 81920
    s_mov_b32 s63, 0
    s_cmov_b32 s63, 122880
    v_add_u32 v240, s61, v247
    v_add_u32 v242, s63, v247
    v_xor_b32 v241, 64, v240
    v_xor_b32 v243, 64, v242
    s_lshl_b32 s63, s69, 13
    s_add_u32 s61, s61, s63
    v_add_u32 v224, s61, v224
    v_xor_b32 v225, 32, v224
    v_xor_b32 v226, 64, v224
    v_xor_b32 v227, 96, v224
    s_lshl_b32 s62, s70, 12
    s_add_u32 s62, s62, s63
    s_add_u32 s62, s62, 40960
    v_add_u32 v244, s62, v235
    v_xor_b32 v245, 16, v244
    s_lshl_b32 s63, s70, 2
    v_add_u32 v250, s63, v232
    v_lshrrev_b32 v228, 1, v246
    ds_read_b128 v[64:67], v232
    s_waitcnt lgkmcnt(0)
    v_min3_u32 v64, v64, v65, v66
    v_min_u32 v64, v64, v67
    s_nop 0
    v_readfirstlane_b32 s71, v64
    s_cmp_lt_u32 s71, 9
    s_cbranch_scc1 L_ov_skip
    ds_read_b64_tr_b16 v[192:193], v248 offset:0
    ds_read_b64_tr_b16 v[194:195], v248 offset:512
    ds_read_b64_tr_b16 v[196:197], v249 offset:0
    ds_read_b64_tr_b16 v[198:199], v249 offset:512
    ds_read_b64_tr_b16 v[200:201], v248 offset:2048
    ds_read_b64_tr_b16 v[202:203], v248 offset:2560
    ds_read_b64_tr_b16 v[204:205], v249 offset:2048
    ds_read_b64_tr_b16 v[206:207], v249 offset:2560
    ds_read_b64_tr_b16 v[208:209], v248 offset:4096
    ds_read_b64_tr_b16 v[210:211], v248 offset:4608
    ds_read_b64_tr_b16 v[212:213], v249 offset:4096
    ds_read_b64_tr_b16 v[214:215], v249 offset:4608
    s_waitcnt lgkmcnt(8)
    ds_read_b64_tr_b16 v[216:217], v248 offset:6144
    ds_read_b64_tr_b16 v[218:219], v248 offset:6656
    ds_read_b64_tr_b16 v[220:221], v249 offset:6144
    ds_read_b64_tr_b16 v[222:223], v249 offset:6656
L_ov_skip:
    s_mov_b32 s65, 0
L_nonce:
    s_waitcnt vmcnt(0)
    v_readfirstlane_b32 s61, v254
    s_add_u32 s65, s65, 1
    s_cmp_lg_u32 s61, 0
    s_cbranch_scc1 L_nonce_ok
    s_cmp_ge_u32 s65, 1048576
    s_cbranch_scc1 L_nonce_ok
    buffer_load_dwordx2 v[254:255], off, s[40:43], 0 sc1
    s_branch L_nonce
L_nonce_ok:
    s_mov_b64 exec, 1
    s_mov_b64 exec, 0xffff
    buffer_store_dwordx2 v[254:255], v228, s[44:47], s76 offen sc1
    s_mov_b64 exec, -1
    s_cmp_lt_u32 s71, 9
    s_cbranch_scc1 L_ov_late
L_ov_done:
    s_waitcnt lgkmcnt(0)
    v_mov_b32 v234, 10
    s_mov_b64 exec, 1
    ds_write_b32 v233, v234
    s_mov_b64 exec, -1
    s_mov_b32 s68, 0
L_go:
    ds_read_b32 v228, v250 offset:32
    s_add_u32 s68, s68, 1
    s_waitcnt lgkmcnt(0)
    v_readfirstlane_b32 s64, v228
    s_cmp_lg_u32 s64, 0
    s_cbranch_scc1 L_gone
    s_cmp_lt_u32 s68, 4194304
    s_cbranch_scc1 L_go
L_gone:
    buffer_load_dwordx4 v[0:3], v246, s[44:47], s75 offen offset:0 sc1
    buffer_load_dwordx4 v[4:7], v246, s[44:47], s75 offen offset:1024 sc1
    buffer_load_dwordx4 v[8:11], v246, s[44:47], s75 offen offset:2048 sc1
    buffer_load_dwordx4 v[12:15], v246, s[44:47], s75 offen offset:3072 sc1
    s_add_u32 s75, s75, 4096
    buffer_load_dwordx4 v[16:19], v246, s[44:47], s75 offen offset:0 sc1
    buffer_load_dwordx4 v[20:23], v246, s[44:47], s75 offen offset:1024 sc1
    buffer_load_dwordx4 v[24:27], v246, s[44:47], s75 offen offset:2048 sc1
    buffer_load_dwordx4 v[28:31], v246, s[44:47], s75 offen offset:3072 sc1
    s_add_u32 s75, s75, 4096
    buffer_load_dwordx4 v[32:35], v246, s[44:47], s75 offen offset:0 sc1
    buffer_load_dwordx4 v[36:39], v246, s[44:47], s75 offen offset:1024 sc1
    s_waitcnt vmcnt(9)
    v_mfma_f32_32x32x16_bf16 v[144:159], v[196:199], v[0:3], 0
    v_mfma_f32_32x32x16_bf16 v[128:143], v[192:195], v[0:3], 0
    buffer_load_dwordx4 v[40:43], v246, s[44:47], s75 offen offset:2048 sc1
    s_waitcnt vmcnt(9)
    v_mfma_f32_32x32x16_bf16 v[144:159], v[204:207], v[4:7], v[144:159]
    ds_read_b64_tr_b16 v[164:165], v241 offset:0
    ds_read_b64_tr_b16 v[166:167], v241 offset:512
    v_mfma_f32_32x32x16_bf16 v[128:143], v[200:203], v[4:7], v[128:143]
    ds_read_b64_tr_b16 v[160:161], v240 offset:0
    ds_read_b64_tr_b16 v[162:163], v240 offset:512
    buffer_load_dwordx4 v[44:47], v246, s[44:47], s75 offen offset:3072 sc1
    s_add_u32 s75, s75, 4096
    s_waitcnt vmcnt(9)
    v_mfma_f32_32x32x16_bf16 v[144:159], v[212:215], v[8:11], v[144:159]
    ds_read_b64_tr_b16 v[172:173], v241 offset:2048
    ds_read_b64_tr_b16 v[174:175], v241 offset:2560
    v_mfma_f32_32x32x16_bf16 v[128:143], v[208:211], v[8:11], v[128:143]
    ds_read_b64_tr_b16 v[168:169], v240 offset:2048
    ds_read_b64_tr_b16 v[170:171], v240 offset:2560
    buffer_load_dwordx4 v[48:51], v246, s[44:47], s75 offen offset:0 sc1
    s_waitcnt vmcnt(9)
    v_mfma_f32_32x32x16_bf16 v[144:159], v[220:223], v[12:15], v[144:159]
    ds_read_b64_tr_b16 v[180:181], v241 offset:4096
    ds_read_b64_tr_b16 v[182:183], v241 offset:4608
    v_mfma_f32_32x32x16_bf16 v[128:143], v[216:219], v[12:15], v[128:143]
    ds_read_b64_tr_b16 v[176:177], v240 offset:4096
    ds_read_b64_tr_b16 v[178:179], v240 offset:4608
    buffer_load_dwordx4 v[52:55], v246, s[44:47], s75 offen offset:1024 sc1
    s_waitcnt vmcnt(9)
    s_waitcnt lgkmcnt(10)
    v_mfma_f32_32x32x16_bf16 v[144:159], v[164:167], v[16:19], v[144:159]
    ds_read_b64_tr_b16 v[188:189], v241 offset:6144
    ds_read_b64_tr_b16 v[190:191], v241 offset:6656
    s_waitcnt lgkmcnt(10)
    v_mfma_f32_32x32x16_bf16 v[128:143], v[160:163], v[16:19], v[128:143]
    ds_read_b64_tr_b16 v[184:185], v240 offset:6144
    ds_read_b64_tr_b16 v[186:187], v240 offset:6656
    buffer_load_dwordx4 v[56:59], v246, s[44:47], s75 offen offset:2048 sc1
    s_waitcnt vmcnt(9)
    s_waitcnt lgkmcnt(10)
    v_mfma_f32_32x32x16_bf16 v[144:159], v[172:175], v[20:23], v[144:159]
    ds_read_b64_tr_b16 v[164:165], v241 offset:8192
    ds_read_b64_tr_b16 v[166:167], v241 offset:8704
    s_waitcnt lgkmcnt(10)
    v_mfma_f32_32x32x16_bf16 v[128:143], v[168:171], v[20:23], v[128:143]
    ds_read_b64_tr_b16 v[160:161], v240 offset:8192
    ds_read_b64_tr_b16 v[162:163], v240 offset:8704
    buffer_load_dwordx4 v[60:63], v246, s[44:47], s75 offen offset:3072 sc1
    s_add_u32 s75, s75, 4096
    s_waitcnt vmcnt(9)
    s_waitcnt lgkmcnt(10)
    v_mfma_f32_32x32x16_bf16 v[144:159], v[180:183], v[24:27], v[144:159]
    ds_read_b64_tr_b16 v[172:173], v241 offset:10240
    ds_read_b64_tr_b16 v[174:175], v241 offset:10752
    s_waitcnt lgkmcnt(10)
    v_mfma_f32_32x32x16_bf16 v[128:143], v[176:179], v[24:27], v[128:143]
    ds_read_b64_tr_b16 v[168:169], v240 offset:10240
    ds_read_b64_tr_b16 v[170:171], v240 offset:10752
    buffer_load_dwordx4 v[64:67], v246, s[44:47], s75 offen offset:0 sc1
    s_waitcnt vmcnt(9)
    s_waitcnt lgkmcnt(10)
    v_mfma_f32_32x32x16_bf16 v[144:159], v[188:191], v[28:31], v[144:159]
    ds_read_b64_tr_b16 v[180:181], v241 offset:12288
    ds_read_b64_tr_b16 v[182:183], v241 offset:12800
    s_waitcnt lgkmcnt(10)
    v_mfma_f32_32x32x16_bf16 v[128:143], v[184:187], v[28:31], v[128:143]
    ds_read_b64_tr_b16 v[176:177], v240 offset:12288
    ds_read_b64_tr_b16 v[178:179], v240 offset:12800
    buffer_load_dwordx4 v[68:71], v246, s[44:47], s75 offen offset:1024 sc1
    s_waitcnt vmcnt(9)
    s_waitcnt lgkmcnt(10)
    v_mfma_f32_32x32x16_bf16 v[144:159], v[164:167], v[32:35], v[144:159]
    ds_read_b64_tr_b16 v[188:189], v241 offset:14336
    ds_read_b64_tr_b16 v[190:191], v241 offset:14848
    s_waitcnt lgkmcnt(10)
    v_mfma_f32_32x32x16_bf16 v[128:143], v[160:163], v[32:35], v[128:143]
    ds_read_b64_tr_b16 v[184:185], v240 offset:14336
    ds_read_b64_tr_b16 v[186:187], v240 offset:14848
    buffer_load_dwordx4 v[72:75], v246, s[44:47], s75 offen offset:2048 sc1
    s_waitcnt vmcnt(9)
    s_waitcnt lgkmcnt(10)
    v_mfma_f32_32x32x16_bf16 v[144:159], v[172:175], v[36:39], v[144:159]
    ds_read_b64_tr_b16 v[164:165], v241 offset:16384
    ds_read_b64_tr_b16 v[166:167], v241 offset:16896
    s_waitcnt lgkmcnt(10)
    v_mfma_f32_32x32x16_bf16 v[128:143], v[168:171], v[36:39], v[128:143]
    ds_read_b64_tr_b16 v[160:161], v240 offset:16384
    ds_read_b64_tr_b16 v[162:163], v240 offset:16896
    buffer_load_dwordx4 v[76:79], v246, s[44:47], s75 offen offset:3072 sc1
    s_add_u32 s75, s75, 4096
    s_waitcnt vmcnt(9)
    s_waitcnt lgkmcnt(10)
    v_mfma_f32_32x32x16_bf16 v[144:159], v[180:183], v[40:43], v[144:159]
    ds_read_b64_tr_b16 v[172:173], v241 offset:18432
    ds_read_b64_tr_b16 v[174:175], v241 offset:18944
    s_waitcnt lgkmcnt(10)
    v_mfma_f32_32x32x16_bf16 v[128:143], v[176:179], v[40:43], v[128:143]
    ds_read_b64_tr_b16 v[168:169], v240 offset:18432
    ds_read_b64_tr_b16 v[170:171], v240 offset:18944
    buffer_load_dwordx4 v[80:83], v246, s[44:47], s75 offen offset:0 sc1
    s_waitcnt vmcnt(9)
    s_waitcnt lgkmcnt(10)
    v_mfma_f32_32x32x16_bf16 v[144:159], v[188:191], v[44:47], v[144:159]
    ds_read_b64_tr_b16 v[180:181], v241 offset:20480
    ds_read_b64_tr_b16 v[182:183], v241 offset:20992
    s_waitcnt lgkmcnt(10)
    v_mfma_f32_32x32x16_bf16 v[128:143], v[184:187], v[44:47], v[128:143]
    ds_read_b64_tr_b16 v[176:177], v240 offset:20480
    ds_read_b64_tr_b16 v[178:179], v240 offset:20992
    buffer_load_dwordx4 v[84:87], v246, s[44:47], s75 offen offset:1024 sc1
    s_waitcnt vmcnt(9)
    s_waitcnt lgkmcnt(10)
    v_mfma_f32_32x32x16_bf16 v[144:159], v[164:167], v[48:51], v[144:159]
    ds_read_b64_tr_b16 v[188:189], v241 offset:22528
    ds_read_b64_tr_b16 v[190:191], v241 offset:23040
    s_waitcnt lgkmcnt(10)
    v_mfma_f32_32x32x16_bf16 v[128:143], v[160:163], v[48:51], v[128:143]
    ds_read_b64_tr_b16 v[184:185], v240 offset:22528
    ds_read_b64_tr_b16 v[186:187], v240 offset:23040
    buffer_load_dwordx4 v[88:91], v246, s[44:47], s75 offen offset:2048 sc1
    s_waitcnt vmcnt(9)
    s_waitcnt lgkmcnt(10)
    v_mfma_f32_32x32x16_bf16 v[144:159], v[172:175], v[52:55], v[144:159]
    ds_read_b64_tr_b16 v[164:165], v241 offset:24576
    ds_read_b64_tr_b16 v[166:167], v241 offset:25088
    s_waitcnt lgkmcnt(10)
    v_mfma_f32_32x32x16_bf16 v[128:143], v[168:171], v[52:55], v[128:143]
    ds_read_b64_tr_b16 v[160:161], v240 offset:24576
    ds_read_b64_tr_b16 v[162:163], v240 offset:25088
    buffer_load_dwordx4 v[92:95], v246, s[44:47], s78 offen offset:0 sc1
    s_waitcnt vmcnt(9)
    s_waitcnt lgkmcnt(10)
    v_mfma_f32_32x32x16_bf16 v[144:159], v[180:183], v[56:59], v[144:159]
    ds_read_b64_tr_b16 v[172:173], v241 offset:26624
    ds_read_b64_tr_b16 v[174:175], v241 offset:27136
    s_waitcnt lgkmcnt(10)
    v_mfma_f32_32x32x16_bf16 v[128:143], v[176:179], v[56:59], v[128:143]
    ds_read_b64_tr_b16 v[168:169], v240 offset:26624
    ds_read_b64_tr_b16 v[170:171], v240 offset:27136
    buffer_load_dwordx4 v[96:99], v246, s[44:47], s78 offen offset:1024 sc1
    s_waitcnt vmcnt(9)
    s_waitcnt lgkmcnt(10)
    v_mfma_f32_32x32x16_bf16 v[144:159], v[188:191], v[60:63], v[144:159]
    ds_read_b64_tr_b16 v[180:181], v241 offset:28672
    ds_read_b64_tr_b16 v[182:183], v241 offset:29184
    s_waitcnt lgkmcnt(10)
    v_mfma_f32_32x32x16_bf16 v[128:143], v[184:187], v[60:63], v[128:143]
    ds_read_b64_tr_b16 v[176:177], v240 offset:28672
    ds_read_b64_tr_b16 v[178:179], v240 offset:29184
    buffer_load_dwordx4 v[100:103], v246, s[44:47], s78 offen offset:2048 sc1
    s_waitcnt vmcnt(9)
    s_waitcnt lgkmcnt(10)
    v_mfma_f32_32x32x16_bf16 v[144:159], v[164:167], v[64:67], v[144:159]
    ds_read_b64_tr_b16 v[188:189], v241 offset:30720
    ds_read_b64_tr_b16 v[190:191], v241 offset:31232
    s_waitcnt lgkmcnt(10)
    v_mfma_f32_32x32x16_bf16 v[128:143], v[160:163], v[64:67], v[128:143]
    ds_read_b64_tr_b16 v[184:185], v240 offset:30720
    ds_read_b64_tr_b16 v[186:187], v240 offset:31232
    buffer_load_dwordx4 v[104:107], v246, s[44:47], s78 offen offset:3072 sc1
    s_add_u32 s78, s78, 4096
    s_waitcnt vmcnt(9)
    s_waitcnt lgkmcnt(10)
    v_mfma_f32_32x32x16_bf16 v[144:159], v[172:175], v[68:71], v[144:159]
    ds_read_b64_tr_b16 v[164:165], v241 offset:32768
    ds_read_b64_tr_b16 v[166:167], v241 offset:33280
    s_waitcnt lgkmcnt(10)
    v_mfma_f32_32x32x16_bf16 v[128:143], v[168:171], v[68:71], v[128:143]
    ds_read_b64_tr_b16 v[160:161], v240 offset:32768
    ds_read_b64_tr_b16 v[162:163], v240 offset:33280
    buffer_load_dwordx4 v[108:111], v246, s[44:47], s78 offen offset:0 sc1
    ds_read_b128 v[228:231], v232 offset:0
    s_waitcnt vmcnt(9)
    s_waitcnt lgkmcnt(11)
    v_mfma_f32_32x32x16_bf16 v[144:159], v[180:183], v[72:75], v[144:159]
    ds_read_b64_tr_b16 v[172:173], v241 offset:34816
    ds_read_b64_tr_b16 v[174:175], v241 offset:35328
    s_waitcnt lgkmcnt(11)
    v_mfma_f32_32x32x16_bf16 v[128:143], v[176:179], v[72:75], v[128:143]
    ds_read_b64_tr_b16 v[168:169], v240 offset:34816
    ds_read_b64_tr_b16 v[170:171], v240 offset:35328
    buffer_load_dwordx4 v[112:115], v246, s[44:47], s78 offen offset:1024 sc1
    s_waitcnt vmcnt(9)
    s_waitcnt lgkmcnt(11)
    v_mfma_f32_32x32x16_bf16 v[144:159], v[188:191], v[76:79], v[144:159]
    ds_read_b64_tr_b16 v[180:181], v241 offset:36864
    ds_read_b64_tr_b16 v[182:183], v241 offset:37376
    s_waitcnt lgkmcnt(11)
    v_mfma_f32_32x32x16_bf16 v[128:143], v[184:187], v[76:79], v[128:143]
    ds_read_b64_tr_b16 v[176:177], v240 offset:36864
    ds_read_b64_tr_b16 v[178:179], v240 offset:37376
    buffer_load_dwordx4 v[116:119], v246, s[44:47], s78 offen offset:2048 sc1
    s_waitcnt lgkmcnt(8)
    v_min3_u32 v228, v228, v229, v230
    v_min_u32 v228, v228, v231
    s_nop 0
    v_readfirstlane_b32 s64, v228
    s_cmp_ge_u32 s64, 10
    s_cbranch_scc0 L_c2_wait
L_c2_go:
    s_waitcnt vmcnt(9)
    v_mfma_f32_32x32x16_bf16 v[144:159], v[164:167], v[80:83], v[144:159]
    ds_read_b64_tr_b16 v[188:189], v243 offset:0
    ds_read_b64_tr_b16 v[190:191], v243 offset:512
    v_mfma_f32_32x32x16_bf16 v[128:143], v[160:163], v[80:83], v[128:143]
    ds_read_b64_tr_b16 v[184:185], v242 offset:0
    ds_read_b64_tr_b16 v[186:187], v242 offset:512
    buffer_load_dwordx4 v[120:123], v246, s[44:47], s78 offen offset:3072 sc1
    s_add_u32 s78, s78, 4096
    s_waitcnt vmcnt(9)
    s_waitcnt lgkmcnt(10)
    v_mfma_f32_32x32x16_bf16 v[144:159], v[172:175], v[84:87], v[144:159]
    ds_read_b64_tr_b16 v[164:165], v243 offset:2048
    ds_read_b64_tr_b16 v[166:167], v243 offset:2560
    s_waitcnt lgkmcnt(10)
    v_mfma_f32_32x32x16_bf16 v[128:143], v[168:171], v[84:87], v[128:143]
    ds_read_b64_tr_b16 v[160:161], v242 offset:2048
    ds_read_b64_tr_b16 v[162:163], v242 offset:2560
    buffer_load_dwordx4 v[124:127], v246, s[44:47], s78 offen offset:0 sc1
    s_waitcnt vmcnt(9)
    s_waitcnt lgkmcnt(10)
    v_mfma_f32_32x32x16_bf16 v[144:159], v[180:183], v[88:91], v[144:159]
    ds_read_b64_tr_b16 v[172:173], v243 offset:4096
    ds_read_b64_tr_b16 v[174:175], v243 offset:4608
    s_waitcnt lgkmcnt(10)
    v_mfma_f32_32x32x16_bf16 v[128:143], v[176:179], v[88:91], v[128:143]
    ds_read_b64_tr_b16 v[168:169], v242 offset:4096
    ds_read_b64_tr_b16 v[170:171], v242 offset:4608
    buffer_load_dwordx4 v[0:3], v246, s[44:47], s78 offen offset:1024 sc1
    s_waitcnt vmcnt(9)
    s_waitcnt lgkmcnt(10)
    v_mfma_f32_32x32x16_bf16 v[144:159], v[188:191], v[92:95], v[144:159]
    ds_read_b64_tr_b16 v[180:181], v243 offset:6144
    ds_read_b64_tr_b16 v[182:183], v243 offset:6656
    s_waitcnt lgkmcnt(10)
    v_mfma_f32_32x32x16_bf16 v[128:143], v[184:187], v[92:95], v[128:143]
    ds_read_b64_tr_b16 v[176:177], v242 offset:6144
    ds_read_b64_tr_b16 v[178:179], v242 offset:6656
    buffer_load_dwordx4 v[4:7], v246, s[44:47], s78 offen offset:2048 sc1
    v_mov_b32 v234, 11
    s_mov_b64 exec, 1
    ds_write_b32 v233, v234
    s_mov_b64 exec, -1
    s_waitcnt vmcnt(9)
    s_waitcnt lgkmcnt(11)
    v_mfma_f32_32x32x16_bf16 v[144:159], v[164:167], v[96:99], v[144:159]
    ds_read_b64_tr_b16 v[188:189], v243 offset:8192
    ds_read_b64_tr_b16 v[190:191], v243 offset:8704
    s_waitcnt lgkmcnt(11)
    v_mfma_f32_32x32x16_bf16 v[128:143], v[160:163], v[96:99], v[128:143]
    ds_read_b64_tr_b16 v[184:185], v242 offset:8192
    ds_read_b64_tr_b16 v[186:187], v242 offset:8704
    buffer_load_dwordx4 v[8:11], v246, s[44:47], s78 offen offset:3072 sc1
    s_add_u32 s78, s78, 4096
    s_waitcnt vmcnt(9)
    s_waitcnt lgkmcnt(11)
    v_mfma_f32_32x32x16_bf16 v[144:159], v[172:175], v[100:103], v[144:159]
    ds_read_b64_tr_b16 v[164:165], v243 offset:10240
    ds_read_b64_tr_b16 v[166:167], v243 offset:10752
    s_waitcnt lgkmcnt(11)
    v_mfma_f32_32x32x16_bf16 v[128:143], v[168:171], v[100:103], v[128:143]
    ds_read_b64_tr_b16 v[160:161], v242 offset:10240
    ds_read_b64_tr_b16 v[162:163], v242 offset:10752
    buffer_load_dwordx4 v[12:15], v246, s[44:47], s78 offen offset:0 sc1
    s_waitcnt vmcnt(9)
    s_waitcnt lgkmcnt(11)
    v_mfma_f32_32x32x16_bf16 v[144:159], v[180:183], v[104:107], v[144:159]
    ds_read_b64_tr_b16 v[172:173], v243 offset:12288
    ds_read_b64_tr_b16 v[174:175], v243 offset:12800
    s_waitcnt lgkmcnt(11)
    v_mfma_f32_32x32x16_bf16 v[128:143], v[176:179], v[104:107], v[128:143]
    ds_read_b64_tr_b16 v[168:169], v242 offset:12288
    ds_read_b64_tr_b16 v[170:171], v242 offset:12800
    buffer_load_dwordx4 v[16:19], v246, s[44:47], s78 offen offset:1024 sc1
    s_waitcnt vmcnt(9)
    s_waitcnt lgkmcnt(10)
    v_mfma_f32_32x32x16_bf16 v[144:159], v[188:191], v[108:111], v[144:159]
    ds_read_b64_tr_b16 v[180:181], v243 offset:14336
    ds_read_b64_tr_b16 v[182:183], v243 offset:14848
    s_waitcnt lgkmcnt(10)
    v_mfma_f32_32x32x16_bf16 v[128:143], v[184:187], v[108:111], v[128:143]
    ds_read_b64_tr_b16 v[176:177], v242 offset:14336
    ds_read_b64_tr_b16 v[178:179], v242 offset:14848
    buffer_load_dwordx4 v[20:23], v246, s[44:47], s78 offen offset:2048 sc1
    s_waitcnt vmcnt(9)
    s_waitcnt lgkmcnt(10)
    v_mfma_f32_32x32x16_bf16 v[144:159], v[164:167], v[112:115], v[144:159]
    ds_read_b64_tr_b16 v[188:189], v243 offset:16384
    ds_read_b64_tr_b16 v[190:191], v243 offset:16896
    s_waitcnt lgkmcnt(10)
    v_mfma_f32_32x32x16_bf16 v[128:143], v[160:163], v[112:115], v[128:143]
    ds_read_b64_tr_b16 v[184:185], v242 offset:16384
    ds_read_b64_tr_b16 v[186:187], v242 offset:16896
    buffer_load_dwordx4 v[24:27], v246, s[44:47], s78 offen offset:3072 sc1
    s_add_u32 s78, s78, 4096
    s_waitcnt vmcnt(9)
    s_waitcnt lgkmcnt(10)
    v_mfma_f32_32x32x16_bf16 v[144:159], v[172:175], v[116:119], v[144:159]
    ds_read_b64_tr_b16 v[164:165], v243 offset:18432
    ds_read_b64_tr_b16 v[166:167], v243 offset:18944
    s_waitcnt lgkmcnt(10)
    v_mfma_f32_32x32x16_bf16 v[128:143], v[168:171], v[116:119], v[128:143]
    ds_read_b64_tr_b16 v[160:161], v242 offset:18432
    ds_read_b64_tr_b16 v[162:163], v242 offset:18944
    buffer_load_dwordx4 v[28:31], v246, s[44:47], s78 offen offset:0 sc1
    s_waitcnt vmcnt(9)
    s_waitcnt lgkmcnt(10)
    v_mfma_f32_32x32x16_bf16 v[144:159], v[180:183], v[120:123], v[144:159]
    ds_read_b64_tr_b16 v[172:173], v243 offset:20480
    ds_read_b64_tr_b16 v[174:175], v243 offset:20992
    s_waitcnt lgkmcnt(10)
    v_mfma_f32_32x32x16_bf16 v[128:143], v[176:179], v[120:123], v[128:143]
    ds_read_b64_tr_b16 v[168:169], v242 offset:20480
    ds_read_b64_tr_b16 v[170:171], v242 offset:20992
    buffer_load_dwordx4 v[32:35], v246, s[44:47], s78 offen offset:1024 sc1
    s_waitcnt vmcnt(9)
    s_waitcnt lgkmcnt(10)
    v_mfma_f32_32x32x16_bf16 v[144:159], v[188:191], v[124:127], v[144:159]
    ds_read_b64_tr_b16 v[180:181], v243 offset:22528
    ds_read_b64_tr_b16 v[182:183], v243 offset:23040
    s_waitcnt lgkmcnt(10)
    v_mfma_f32_32x32x16_bf16 v[128:143], v[184:187], v[124:127], v[128:143]
    ds_read_b64_tr_b16 v[176:177], v242 offset:22528
    ds_read_b64_tr_b16 v[178:179], v242 offset:23040
    buffer_load_dwordx4 v[36:39], v246, s[44:47], s78 offen offset:2048 sc1
    s_waitcnt vmcnt(9)
    s_waitcnt lgkmcnt(10)
    v_mfma_f32_32x32x16_bf16 v[144:159], v[164:167], v[0:3], v[144:159]
    ds_read_b64_tr_b16 v[188:189], v243 offset:24576
    ds_read_b64_tr_b16 v[190:191], v243 offset:25088
    s_waitcnt lgkmcnt(10)
    v_mfma_f32_32x32x16_bf16 v[128:143], v[160:163], v[0:3], v[128:143]
    ds_read_b64_tr_b16 v[184:185], v242 offset:24576
    ds_read_b64_tr_b16 v[186:187], v242 offset:25088
    buffer_load_dwordx4 v[40:43], v246, s[44:47], s78 offen offset:3072 sc1
    s_add_u32 s78, s78, 4096
    s_waitcnt vmcnt(9)
    s_waitcnt lgkmcnt(10)
    v_mfma_f32_32x32x16_bf16 v[144:159], v[172:175], v[4:7], v[144:159]
    ds_read_b64_tr_b16 v[164:165], v243 offset:26624
    ds_read_b64_tr_b16 v[166:167], v243 offset:27136
    s_waitcnt lgkmcnt(10)
    v_mfma_f32_32x32x16_bf16 v[128:143], v[168:171], v[4:7], v[128:143]
    ds_read_b64_tr_b16 v[160:161], v242 offset:26624
    ds_read_b64_tr_b16 v[162:163], v242 offset:27136
    s_waitcnt vmcnt(8)
    s_waitcnt lgkmcnt(10)
    v_mfma_f32_32x32x16_bf16 v[144:159], v[180:183], v[8:11], v[144:159]
    ds_read_b64_tr_b16 v[172:173], v243 offset:28672
    ds_read_b64_tr_b16 v[174:175], v243 offset:29184
    s_waitcnt lgkmcnt(10)
    v_mfma_f32_32x32x16_bf16 v[128:143], v[176:179], v[8:11], v[128:143]
    ds_read_b64_tr_b16 v[168:169], v242 offset:28672
    ds_read_b64_tr_b16 v[170:171], v242 offset:29184
    s_waitcnt vmcnt(7)
    s_waitcnt lgkmcnt(10)
    v_mfma_f32_32x32x16_bf16 v[144:159], v[188:191], v[12:15], v[144:159]
    ds_read_b64_tr_b16 v[180:181], v243 offset:30720
    ds_read_b64_tr_b16 v[182:183], v243 offset:31232
    s_waitcnt lgkmcnt(10)
    v_mfma_f32_32x32x16_bf16 v[128:143], v[184:187], v[12:15], v[128:143]
    ds_read_b64_tr_b16 v[176:177], v242 offset:30720
    ds_read_b64_tr_b16 v[178:179], v242 offset:31232
    s_waitcnt vmcnt(6)
    s_waitcnt lgkmcnt(10)
    v_mfma_f32_32x32x16_bf16 v[144:159], v[164:167], v[16:19], v[144:159]
    ds_read_b64_tr_b16 v[188:189], v243 offset:32768
    ds_read_b64_tr_b16 v[190:191], v243 offset:33280
    s_waitcnt lgkmcnt(10)
    v_mfma_f32_32x32x16_bf16 v[128:143], v[160:163], v[16:19], v[128:143]
    ds_read_b64_tr_b16 v[184:185], v242 offset:32768
    ds_read_b64_tr_b16 v[186:187], v242 offset:33280
    s_waitcnt vmcnt(5)
    s_waitcnt lgkmcnt(10)
    v_mfma_f32_32x32x16_bf16 v[144:159], v[172:175], v[20:23], v[144:159]
    ds_read_b64_tr_b16 v[164:165], v243 offset:34816
    ds_read_b64_tr_b16 v[166:167], v243 offset:35328
    s_waitcnt lgkmcnt(10)
    v_mfma_f32_32x32x16_bf16 v[128:143], v[168:171], v[20:23], v[128:143]
    ds_read_b64_tr_b16 v[160:161], v242 offset:34816
    ds_read_b64_tr_b16 v[162:163], v242 offset:35328
    ds_read_b128 v[228:231], v232 offset:16
    s_waitcnt vmcnt(4)
    s_waitcnt lgkmcnt(11)
    v_mfma_f32_32x32x16_bf16 v[144:159], v[180:183], v[24:27], v[144:159]
    ds_read_b64_tr_b16 v[172:173], v243 offset:36864
    ds_read_b64_tr_b16 v[174:175], v243 offset:37376
    s_waitcnt lgkmcnt(11)
    v_mfma_f32_32x32x16_bf16 v[128:143], v[176:179], v[24:27], v[128:143]
    ds_read_b64_tr_b16 v[168:169], v242 offset:36864
    ds_read_b64_tr_b16 v[170:171], v242 offset:37376
    s_waitcnt vmcnt(3)
    s_waitcnt lgkmcnt(11)
    v_mfma_f32_32x32x16_bf16 v[144:159], v[188:191], v[28:31], v[144:159]
    ds_read_b64_tr_b16 v[180:181], v243 offset:38912
    ds_read_b64_tr_b16 v[182:183], v243 offset:39424
    s_waitcnt lgkmcnt(11)
    v_mfma_f32_32x32x16_bf16 v[128:143], v[184:187], v[28:31], v[128:143]
    ds_read_b64_tr_b16 v[176:177], v242 offset:38912
    ds_read_b64_tr_b16 v[178:179], v242 offset:39424
    s_waitcnt lgkmcnt(8)
    v_min3_u32 v228, v228, v229, v230
    v_min_u32 v228, v228, v231
    s_nop 0
    v_readfirstlane_b32 s64, v228
    s_cmp_ge_u32 s64, 11
    s_cbranch_scc0 L_ex_wait
L_ex_go:
    s_waitcnt vmcnt(2)
    v_mfma_f32_32x32x16_bf16 v[144:159], v[164:167], v[32:35], v[144:159]
    s_waitcnt vmcnt(1)
    s_waitcnt lgkmcnt(6)
    v_mfma_f32_32x32x16_bf16 v[144:159], v[172:175], v[36:39], v[144:159]
    s_waitcnt vmcnt(0)
    s_waitcnt lgkmcnt(2)
    v_mfma_f32_32x32x16_bf16 v[144:159], v[180:183], v[40:43], v[144:159]
    s_waitcnt lgkmcnt(0)
    v_mfma_f32_32x32x16_bf16 v[128:143], v[160:163], v[32:35], v[128:143]
    s_nop 9
    v_mfma_f32_32x32x16_bf16 v[128:143], v[168:171], v[36:39], v[128:143]
    ds_write_b128 v224, v[144:147] offset:128
    v_mfma_f32_32x32x16_bf16 v[128:143], v[176:179], v[40:43], v[128:143]
    ds_write_b128 v225, v[148:151] offset:128
    ds_write_b128 v226, v[152:155] offset:128
    ds_write_b128 v227, v[156:159] offset:128
    s_add_u32 s61, s77, 8192
    s_nop 7
    ds_write_b128 v224, v[128:131]
    ds_write_b128 v225, v[132:135]
    ds_write_b128 v226, v[136:139]
    ds_write_b128 v227, v[140:143]
    s_waitcnt lgkmcnt(0)
    s_barrier
    ds_read_b128 v[64:67], v244 offset:0
    ds_read_b128 v[68:71], v245 offset:0
    ds_read_b128 v[72:75], v244 offset:40960
    ds_read_b128 v[76:79], v245 offset:40960
    ds_read_b128 v[80:83], v244 offset:2048
    ds_read_b128 v[84:87], v245 offset:2048
    ds_read_b128 v[88:91], v244 offset:43008
    ds_read_b128 v[92:95], v245 offset:43008
    s_waitcnt lgkmcnt(4)
    v_pk_add_f32 v[64:65], v[64:65], v[72:73]
    v_pk_add_f32 v[66:67], v[66:67], v[74:75]
    v_pk_add_f32 v[68:69], v[68:69], v[76:77]
    v_pk_add_f32 v[70:71], v[70:71], v[78:79]
    v_cvt_pk_bf16_f32 v96, v64, v65
    v_cvt_pk_bf16_f32 v97, v66, v67
    v_cvt_pk_bf16_f32 v98, v68, v69
    v_cvt_pk_bf16_f32 v99, v70, v71
    buffer_store_dwordx4 v[96:99], v236, s[36:39], s77 offen
    s_waitcnt lgkmcnt(0)
    v_pk_add_f32 v[80:81], v[80:81], v[88:89]
    v_pk_add_f32 v[82:83], v[82:83], v[90:91]
    v_pk_add_f32 v[84:85], v[84:85], v[92:93]
    v_pk_add_f32 v[86:87], v[86:87], v[94:95]
    v_cvt_pk_bf16_f32 v100, v80, v81
    v_cvt_pk_bf16_f32 v101, v82, v83
    v_cvt_pk_bf16_f32 v102, v84, v85
    v_cvt_pk_bf16_f32 v103, v86, v87
    buffer_store_dwordx4 v[100:103], v236, s[36:39], s61 offen
L_end:
    s_endpgm
L_c2_wait:
    s_mov_b32 s68, 0
L_spin_4:
    ds_read_b128 v[228:231], v232 offset:0
    s_add_u32 s68, s68, 1
    s_waitcnt lgkmcnt(0)
    v_min3_u32 v228, v228, v229, v230
    v_min_u32 v228, v228, v231
    s_nop 0
    v_readfirstlane_b32 s64, v228
    s_cmp_ge_u32 s64, 10
    s_cbranch_scc1 L_spun_5
    s_cmp_lt_u32 s68, 1048576
    s_cbranch_scc1 L_spin_4
L_spun_5:
    s_branch L_c2_go
L_ex_wait:
    s_mov_b32 s68, 0
L_spin_6:
    ds_read_b128 v[228:231], v232 offset:16
    s_add_u32 s68, s68, 1
    s_waitcnt lgkmcnt(0)
    v_min3_u32 v228, v228, v229, v230
    v_min_u32 v228, v228, v231
    s_nop 0
    v_readfirstlane_b32 s64, v228
    s_cmp_ge_u32 s64, 11
    s_cbranch_scc1 L_spun_7
    s_cmp_lt_u32 s68, 1048576
    s_cbranch_scc1 L_spin_6
L_spun_7:
    s_branch L_ex_go
L_ov_late:
    s_mov_b32 s68, 0
L_spin_8:
    ds_read_b128 v[228:231], v232 offset:0
    s_add_u32 s68, s68, 1
    s_waitcnt lgkmcnt(0)
    v_min3_u32 v228, v228, v229, v230
    v_min_u32 v228, v228, v231
    s_nop 0
    v_readfirstlane_b32 s64, v228
    s_cmp_ge_u32 s64, 9
    s_cbranch_scc1 L_spun_9
    s_cmp_lt_u32 s68, 1048576
    s_cbranch_scc1 L_spin_8
L_spun_9:
    ds_read_b64_tr_b16 v[192:193], v248 offset:0
    ds_read_b64_tr_b16 v[194:195], v248 offset:512
    ds_read_b64_tr_b16 v[196:197], v249 offset:0
    ds_read_b64_tr_b16 v[198:199], v249 offset:512
    ds_read_b64_tr_b16 v[200:201], v248 offset:2048
    ds_read_b64_tr_b16 v[202:203], v248 offset:2560
    ds_read_b64_tr_b16 v[204:205], v249 offset:2048
    ds_read_b64_tr_b16 v[206:207], v249 offset:2560
    ds_read_b64_tr_b16 v[208:209], v248 offset:4096
    ds_read_b64_tr_b16 v[210:211], v248 offset:4608
    ds_read_b64_tr_b16 v[212:213], v249 offset:4096
    ds_read_b64_tr_b16 v[214:215], v249 offset:4608
    s_waitcnt lgkmcnt(8)
    ds_read_b64_tr_b16 v[216:217], v248 offset:6144
    ds_read_b64_tr_b16 v[218:219], v248 offset:6656
    ds_read_b64_tr_b16 v[220:221], v249 offset:6144
    ds_read_b64_tr_b16 v[222:223], v249 offset:6656
    s_branch L_ov_done
L_codeend:
.section .rodata,"a"
.p2align 6
.amdhsa_kernel standalone__glu_gated_swiglu__prompt_kernel
  .amdhsa_next_free_vgpr 256
  .amdhsa_next_free_sgpr 102
  .amdhsa_accum_offset 256
  .amdhsa_group_segment_fixed_size 0
  .amdhsa_kernarg_size 56
  .amdhsa_user_sgpr_count 2
  .amdhsa_user_sgpr_kernarg_segment_ptr 1
  .amdhsa_system_sgpr_workgroup_id_x 1
.end_amdhsa_kernel
```
